```python
import torch

def _softmax(x, axis=-1):
    return torch.softmax(x, dim=axis)
def _gelu(x):
    return torch.nn.functional.gelu(x, approximate="tanh")
def _silu(x):
    return torch.nn.functional.silu(x)
def _sigmoid(x):
    return torch.sigmoid(x)
def _layernorm(x, axis=-1, eps=1e-5):
    m = x.mean(dim=axis, keepdim=True)
    v = x.var(dim=axis, keepdim=True, unbiased=False)
    return (x - m) / torch.sqrt(v + eps)
def _scatter_add(tgt, idx, src, axis=0):
    return tgt.clone().index_add_(axis, idx, src)
def _segment_sum(src, seg, n):
    out = torch.zeros((n,) + src.shape[1:], dtype=src.dtype)
    return out.index_add_(0, seg, src)
def _pad(x, pw):
    flat = tuple(v for pair in reversed(pw) for v in pair)
    return torch.nn.functional.pad(x, flat)

kernel_name = 'standalone__self_sup_conv_stem_hubert__speech'

def setup_inputs():

    _w = (lambda a: (lambda t: t.to(torch.bfloat16) if t.is_floating_point() else t)(torch.as_tensor(a)))
    B, T, D, K = 2, 1000, 512, 31
    scale = (1.0 / (K * D)) ** 0.5
    return {
        "x": _w((lambda *s: torch.randn(*s, dtype=torch.bfloat16) * 0.05)(B, T, D)),
        "w": _w((lambda *s: torch.randn(*s, dtype=torch.bfloat16) * 0.05)(K, D, D) * scale),
        "b": _w((lambda *s: torch.randn(*s, dtype=torch.bfloat16) * 0.05)(D) * 0.1),
        "gamma": _w(torch.ones((D,), dtype=float)),
        "beta": _w(torch.zeros((D,), dtype=float)),
    }

def reference(x, w, b, gamma, beta):
    B, T, D = x.shape
    K = w.shape[0]
    s = 2
    L = (T - K) // s + 1
    y = torch.einsum('blc,cd->bld', x[:, 0 : s * L : s, :], w[0])
    for i in range(1, K):
        y = y + torch.einsum('blc,cd->bld', x[:, i : i + s * L : s, :], w[i])
    y = y + b[None, None, :]
    mu = y.mean(1, keepdims=True)
    var = ((y - mu) ** 2).mean(1, keepdims=True)
    yn = (y - mu) / torch.sqrt(var + 1e-5)
    yn = yn * gamma[None, None, :] + beta[None, None, :]
    return _gelu(yn)
```

```asm
; @launch grid=(256,1,1) block=(512,1,1) lds=160256
.amdgcn_target "amdgcn-amd-amdhsa--gfx950"
.text
.globl standalone__self_sup_conv_stem_hubert__speech_kernel
.p2align 12
.p2align 8
.type standalone__self_sup_conv_stem_hubert__speech_kernel,@function
standalone__self_sup_conv_stem_hubert__speech_kernel:
    s_cmp_ge_u32 s2, 256
    s_cbranch_scc1 L_END0
    s_load_dwordx8 s[4:11], s[0:1], 0
    s_load_dwordx8 s[12:19], s[0:1], 32
    v_lshrrev_b32 v16, 6, v0
    v_and_b32 v17, 63, v0
    s_and_b32 s42, s2, 7
    v_readfirstlane_b32 s40, v16
    s_bfe_u32 s47, s2, 0x40003
    s_lshr_b32 s43, s2, 7
    s_and_b32 s41, s47, 7
    s_lshr_b32 s44, s47, 3
    s_and_b32 s45, s40, 3
    s_lshl_b32 s46, s43, 3
    s_add_u32 s46, s46, s42
    s_mul_i32 s52, s43, 1024000
    s_lshl_b32 s48, s44, 19
    s_add_u32 s52, s52, s48
    s_lshl_b32 s48, s41, 7
    s_add_u32 s52, s52, s48
    s_and_b32 s48, s41, 1
    s_lshl_b32 s48, s48, 14
    s_sub_u32 s52, s52, s48
    s_lshl_b32 s48, s45, 15
    s_add_u32 s60, s52, s48
    s_lshl_b32 s61, s45, 11
    s_and_b32 s48, s42, 1
    s_lshl_b32 s49, s48, 18
    s_add_u32 s50, s60, s49
    s_xor_b32 s49, s49, 0x40000
    s_add_u32 s60, s60, s49
    s_lshl_b32 s49, s48, 14
    s_add_u32 s51, s61, s49
    s_xor_b32 s49, s49, 0x4000
    s_add_u32 s61, s61, s49
    v_lshrrev_b32 v18, 4, v17
    v_lshlrev_b32 v18, 12, v18
    v_bfe_u32 v19, v17, 3, 1
    v_lshl_add_u32 v18, v19, 11, v18
    v_and_b32 v19, 7, v17
    v_lshl_add_u32 v22, v19, 4, v18
    s_lshl_b32 s48, s45, 5
    v_xor_b32 v20, s48, v22
    v_xor_b32 v21, 0x800, v20
    s_add_u32 s48, s43, 1
    s_mul_i32 s22, s48, 1024000
    s_mov_b32 s23, 0x20000
    s_cmp_ge_u32 s40, 4
    s_cbranch_scc0 L_COMPUTE
    s_getpc_b64 s[56:57]
L_PC:
    s_lshr_b32 s48, s2, 3
    s_lshl_b32 s48, s48, 2
    s_add_u32 s48, s48, s45
    s_lshl_b32 s48, s48, 8
    v_lshl_add_u32 v30, v17, 7, s48
    v_min_u32 v30, L_CODE_END-L_PC-4, v30
    s_mov_b64 exec, 3
    global_load_dword v31, v30, s[56:57]
    s_mov_b64 exec, -1
    s_and_b32 s48, s45, 1
    s_add_u32 s48, s48, 32
    s_lshl_b32 s53, s48, 10
    s_lshl_b32 s48, s48, 14
    s_add_u32 s52, s52, s48
    v_lshrrev_b32 v26, 3, v17
    s_lshl_b32 s48, s45, 3
    v_add_u32 v26, s48, v26
    v_lshlrev_b32 v26, 10, v26
    v_bfe_u32 v27, v17, 4, 1
    s_and_b32 s48, s45, 1
    s_lshl_b32 s48, s48, 1
    v_or_b32 v27, s48, v27
    v_lshlrev_b32 v27, 1, v27
    v_xor_b32 v27, v27, v19
    v_lshl_add_u32 v26, v27, 4, v26
    s_lshl_b32 s48, s42, 7
    s_lshl_b32 s49, s41, 16
    s_add_u32 s48, s48, s49
    s_lshl_b32 s49, s43, 15
    s_add_u32 s48, s48, s49
    v_add_u32 v26, s48, v26
    v_xor_b32 v27, 0x8000, v26
    s_lshl_b32 s54, s45, 10
    s_add_u32 s54, s54, 69632
    s_mov_b32 s26, 16252928
    s_mov_b32 s27, 0x20000
    s_waitcnt lgkmcnt(0)
    s_mov_b32 s24, s6
    s_and_b32 s25, s7, 0xffff
    s_mov_b32 s20, s4
    s_and_b32 s21, s5, 0xffff
    s_add_u32 m0, s54, 0
    s_mov_b32 s48, 0
    buffer_load_dwordx4 v26, s[24:27], s48 offen lds
    s_add_u32 m0, s54, 4096
    s_mov_b32 s48, 1048576
    buffer_load_dwordx4 v26, s[24:27], s48 offen lds
    s_add_u32 m0, s54, 8192
    s_mov_b32 s48, 2097152
    buffer_load_dwordx4 v26, s[24:27], s48 offen lds
    s_add_u32 m0, s54, 12288
    s_mov_b32 s48, 3145728
    buffer_load_dwordx4 v26, s[24:27], s48 offen lds
    s_add_u32 m0, s51, 0
    s_add_u32 s48, s50, 0
    s_max_i32 s48, s48, 0
    buffer_load_dwordx4 v20, s[20:23], s48 offen lds
    s_add_u32 m0, s51, 8192
    s_add_u32 s48, s50, 131072
    buffer_load_dwordx4 v21, s[20:23], s48 offen lds
    s_add_u32 m0, s61, 0
    s_add_u32 s48, s60, 0
    s_max_i32 s48, s48, 0
    buffer_load_dwordx4 v20, s[20:23], s48 offen lds
    s_add_u32 m0, s61, 8192
    s_add_u32 s48, s60, 131072
    buffer_load_dwordx4 v21, s[20:23], s48 offen lds
    s_add_u32 m0, s53, 0
    s_add_u32 s48, s52, 0
    buffer_load_dwordx4 v22, s[20:23], s48 offen lds
    s_branch L_LOADLOOP
L_END0:
    s_endpgm
L_COMPUTE:
    v_and_b32 v23, 15, v17
    v_lshrrev_b32 v16, 4, v17
    v_add_u32 v18, 0, v23
    v_and_b32 v18, 7, v18
    v_lshlrev_b32 v18, 1, v18
    v_xor_b32 v18, v16, v18
    v_lshlrev_b32 v18, 4, v18
    v_lshl_add_u32 v220, v23, 11, v18
    s_lshl_b32 s48, s43, 6
    v_xor_b32 v220, s48, v220
    v_add_u32 v18, 1, v23
    v_and_b32 v18, 7, v18
    v_lshlrev_b32 v18, 1, v18
    v_xor_b32 v18, v16, v18
    v_lshlrev_b32 v18, 4, v18
    v_lshl_add_u32 v224, v23, 11, v18
    s_lshl_b32 s48, s43, 6
    v_xor_b32 v224, s48, v224
    s_waitcnt lgkmcnt(0)
    s_mov_b32 s20, s4
    s_and_b32 s21, s5, 0xffff
    s_add_u32 m0, s51, 1024
    s_add_u32 s48, s50, 16384
    buffer_load_dwordx4 v20, s[20:23], s48 offen lds
    s_add_u32 m0, s51, 9216
    s_add_u32 s48, s50, 147456
    buffer_load_dwordx4 v21, s[20:23], s48 offen lds
    s_add_u32 m0, s61, 1024
    s_add_u32 s48, s60, 16384
    buffer_load_dwordx4 v20, s[20:23], s48 offen lds
    s_add_u32 m0, s61, 9216
    s_add_u32 s48, s60, 147456
    buffer_load_dwordx4 v21, s[20:23], s48 offen lds
    s_lshl_b32 s48, s42, 7
    s_lshl_b32 s49, s47, 3
    s_add_u32 s48, s48, s49
    s_load_dwordx2 s[8:9], s[8:9], s48
    s_load_dwordx2 s[10:11], s[10:11], s48
    s_load_dwordx2 s[12:13], s[12:13], s48
    s_mov_b32 s28, s18
    s_and_b32 s29, s19, 0xffff
    s_mov_b32 s30, 12599296
    s_mov_b32 s31, 0x20000
    s_mov_b32 s36, s14
    s_and_b32 s37, s15, 0xffff
    s_mov_b32 s38, 993280
    s_mov_b32 s39, 0x20000
    v_xor_b32 v221, 64, v220
    v_xor_b32 v222, 128, v220
    v_xor_b32 v223, 192, v220
    v_xor_b32 v225, 64, v224
    v_xor_b32 v226, 128, v224
    v_xor_b32 v227, 192, v224
    v_lshrrev_b32 v18, 2, v23
    v_lshl_add_u32 v18, v16, 3, v18
    v_lshlrev_b32 v18, 7, v18
    v_lshrrev_b32 v19, 3, v23
    v_and_b32 v26, 1, v16
    v_lshl_or_b32 v19, v26, 1, v19
    v_xor_b32 v19, s40, v19
    v_lshl_add_u32 v18, v19, 5, v18
    v_and_b32 v19, 3, v23
    v_lshl_add_u32 v18, v19, 3, v18
    v_add_u32 v228, 69632, v18
    v_add_u32 v229, 114688, v18
    s_lshl_b32 s48, s40, 2
    v_add_u32 v6, s48, v16
    v_lshlrev_b32 v6, 10, v6
    v_lshl_add_u32 v6, v23, 4, v6
    s_lshl_b32 s55, s46, 4
    s_add_u32 s55, s55, s47
    s_lshl_b32 s55, s55, 14
    s_lshl_b32 s58, s46, 18
    s_xor_b32 s48, s47, 1
    s_lshl_b32 s48, s48, 14
    s_lshl_b32 s49, s40, 12
    s_add_u32 s48, s48, s49
    s_and_b32 s49, s41, 1
    s_lshl_b32 s59, s49, 4
    s_sub_u32 s48, s48, s59
    v_lshl_add_u32 v230, v17, 4, s48
    s_cmp_eq_u32 s44, 1
    s_cselect_b32 s59, 0xfffe0100, 0
    s_cselect_b32 s57, 0, 0x40000000
    s_add_u32 s59, s59, s57
    s_cmp_eq_u32 s49, 1
    s_cselect_b32 s59, s59, 0
    v_cmp_eq_u32 vcc, 0, v23
    v_mov_b32 v18, s59
    s_nop 0
    v_cndmask_b32 v18, 0, v18, vcc
    v_add_u32 v230, v230, v18
    s_xor_b32 s48, s47, 1
    s_lshl_b32 s48, s48, 5
    s_lshl_b32 s57, s40, 3
    s_add_u32 s48, s48, s57
    s_add_u32 s48, s48, 512
    s_lshl_b32 s49, s49, 8
    s_or_b32 s49, s49, 4
    v_and_b32 v18, 1, v17
    v_mul_u32_u24 v18, s49, v18
    v_xor_b32 v231, s48, v18
    s_lshl_b32 s59, s46, 10
    s_add_u32 s59, s59, 12582912
    s_lshl_b32 s62, s40, 6
    s_add_u32 s62, s62, s59
    s_lshl_b32 s48, s44, 5
    s_add_u32 s62, s62, s48
    s_and_b32 s48, s41, 1
    s_lshl_b32 s48, s48, 4
    s_add_u32 s62, s62, s48
    s_lshr_b32 s48, s41, 1
    s_lshl_b32 s48, s48, 2
    s_add_u32 s62, s62, s48
    s_lshl_b32 s48, s40, 12
    v_lshl_add_u32 v232, v17, 4, s48
    v_mov_b32 v8, 1
    v_mov_b32 v9, 0
    v_mov_b32 v7, 159744
    s_mov_b64 exec, 0
    s_cmp_eq_u32 s45, 0
    s_cbranch_scc1 L_PAD1
    s_cmp_eq_u32 s45, 1
    s_cbranch_scc1 L_PAD3
    s_cmp_eq_u32 s45, 2
    s_cbranch_scc1 L_PAD5
    s_cmp_eq_u32 s45, 3
    s_cbranch_scc1 L_PAD7
L_PADRETC:
    s_mov_b64 exec, -1
    s_lshl_b32 s56, s46, 4
    s_lshr_b32 s49, s40, 2
    s_lshl_b32 s49, s49, 3
    s_add_u32 s56, s56, s49
    s_bfe_u32 s49, s40, 0x10001
    s_add_u32 s56, s56, s49
    s_lshl_b32 s56, s56, 14
    s_lshl_b32 s49, s47, 10
    s_add_u32 s56, s56, s49
    s_lshl_b32 s60, s46, 10
    s_add_u32 s60, s60, 12582912
    s_lshr_b32 s49, s47, 2
    s_lshl_b32 s49, s49, 6
    s_add_u32 s60, s60, s49
    s_lshr_b32 s49, s40, 1
    s_lshl_b32 s49, s49, 4
    s_add_u32 s60, s60, s49
    v_and_b32 v3, 7, v0
    v_lshlrev_b32 v24, 5, v3
    v_and_b32 v3, 3, v0
    v_lshlrev_b32 v3, 2, v3
    v_bfe_u32 v15, v0, 5, 1
    v_and_b32 v1, 31, v0
    v_lshlrev_b32 v1, 4, v1
    v_lshl_add_u32 v1, v15, 16, v1
    s_and_b32 s49, s40, 1
    s_lshl_b32 s49, s49, 9
    v_add_u32 v1, s49, v1
    v_and_b32 v2, 15, v0
    v_lshl_add_u32 v2, v2, 4, v15
    v_bfe_u32 v15, v0, 4, 1
    v_lshl_add_u32 v2, v15, 1, v2
    s_lshr_b32 s49, s40, 2
    s_lshl_b32 s49, s49, 8
    s_xor_b32 s48, s45, 2
    s_lshl_b32 s48, s48, 2
    s_add_u32 s49, s49, s48
    v_add_u32 v2, s49, v2
    s_movk_i32 s49, 485
    v_cmp_gt_u32 s[24:25], s49, v2
    s_mul_i32 s49, s43, 485
    v_add_u32 v2, s49, v2
    v_lshlrev_b32 v2, 10, v2
    s_lshl_b32 s48, s42, 7
    s_lshl_b32 s49, s47, 3
    s_add_u32 s48, s48, s49
    v_add_u32 v2, s48, v2
    v_lshrrev_b32 v4, 3, v0
    v_lshlrev_b32 v4, 2, v4
    v_add_u32 v4, 160000, v4
    v_bfe_u32 v15, v0, 3, 3
    v_lshl_add_u32 v5, v15, 2, v24
    v_add_u32 v5, 160000, v5
    v_mov_b32 v12, 0xc0135761
    v_mov_b32 v13, 0xc0135761
    s_mov_b32 s20, 0xbdd2d3e8
    s_mov_b32 s21, 0xbdd2d3e8
    s_mov_b32 s22, 1.0
    s_mov_b32 s23, 1.0
    s_mov_b32 s26, 0x3b072033
    s_mov_b32 s27, 0xffff0000
    s_mov_b32 s63, 40000
    s_waitcnt lgkmcnt(0)
    s_lshl_b32 s4, s8, 16
    s_and_b32 s5, s8, 0xffff0000
    s_lshl_b32 s6, s9, 16
    s_and_b32 s7, s9, 0xffff0000
    s_mov_b32 vcc_lo, 0
    s_mov_b32 vcc_hi, -1
    v_mov_b32 v11, s10
    v_mov_b32 v24, s11
    v_mov_b32 v14, s12
    v_mov_b32 v25, s13
    v_cndmask_b32 v11, v11, v24, vcc
    v_cndmask_b32 v14, v14, v25, vcc
    s_mov_b32 vcc_lo, 0xffff0000
    s_mov_b32 vcc_hi, 0xffff0000
    v_lshlrev_b32 v24, 16, v11
    v_lshlrev_b32 v25, 16, v14
    v_and_b32 v11, 0xffff0000, v11
    v_and_b32 v14, 0xffff0000, v14
    v_cndmask_b32 v11, v24, v11, vcc
    v_cndmask_b32 v14, v25, v14, vcc
    s_waitcnt vmcnt(0)
    s_barrier
    ds_read_b64_tr_b16 v[80:81], v228 offset:0
    ds_read_b64_tr_b16 v[82:83], v228 offset:512
    ds_read_b128 v[124:127], v220 offset:1024
    ds_read_b128 v[128:131], v222 offset:1024
    ds_read_b128 v[132:135], v220 offset:1280
    ds_read_b128 v[136:139], v222 offset:1280
    ds_read_b128 v[140:143], v220 offset:1536
    ds_read_b128 v[144:147], v222 offset:1536
    ds_read_b128 v[148:151], v220 offset:1792
    ds_read_b128 v[152:155], v222 offset:1792
    s_waitcnt lgkmcnt(7)
    v_mfma_f32_16x16x32_bf16 v[48:51], v[80:83], v[124:127], 0
    ds_read_b64_tr_b16 v[84:85], v228 offset:4096
    s_waitcnt lgkmcnt(7)
    v_mfma_f32_16x16x32_bf16 v[52:55], v[80:83], v[128:131], 0
    ds_read_b64_tr_b16 v[86:87], v228 offset:4608
    s_waitcnt lgkmcnt(7)
    v_mfma_f32_16x16x32_bf16 v[56:59], v[80:83], v[132:135], 0
    ds_read_b64_tr_b16 v[88:89], v228 offset:8192
    s_waitcnt lgkmcnt(7)
    v_mfma_f32_16x16x32_bf16 v[60:63], v[80:83], v[136:139], 0
    ds_read_b64_tr_b16 v[90:91], v228 offset:8704
    s_waitcnt lgkmcnt(7)
    v_mfma_f32_16x16x32_bf16 v[64:67], v[80:83], v[140:143], 0
    s_waitcnt lgkmcnt(6)
    v_mfma_f32_16x16x32_bf16 v[68:71], v[80:83], v[144:147], 0
    s_waitcnt lgkmcnt(5)
    v_mfma_f32_16x16x32_bf16 v[72:75], v[80:83], v[148:151], 0
    s_waitcnt lgkmcnt(4)
    v_mfma_f32_16x16x32_bf16 v[76:79], v[80:83], v[152:155], 0
    s_waitcnt lgkmcnt(2)
    v_mfma_f32_16x16x32_bf16 v[44:47], v[84:87], v[124:127], 0
    ds_read_b64_tr_b16 v[80:81], v228 offset:12288
    v_mfma_f32_16x16x32_bf16 v[48:51], v[84:87], v[128:131], v[48:51]
    ds_read_b64_tr_b16 v[82:83], v228 offset:12800
    v_mfma_f32_16x16x32_bf16 v[52:55], v[84:87], v[132:135], v[52:55]
    v_mfma_f32_16x16x32_bf16 v[56:59], v[84:87], v[136:139], v[56:59]
    v_mfma_f32_16x16x32_bf16 v[60:63], v[84:87], v[140:143], v[60:63]
    v_mfma_f32_16x16x32_bf16 v[64:67], v[84:87], v[144:147], v[64:67]
    v_mfma_f32_16x16x32_bf16 v[68:71], v[84:87], v[148:151], v[68:71]
    v_mfma_f32_16x16x32_bf16 v[72:75], v[84:87], v[152:155], v[72:75]
    s_waitcnt lgkmcnt(2)
    v_mfma_f32_16x16x32_bf16 v[40:43], v[88:91], v[124:127], 0
    ds_read_b64_tr_b16 v[84:85], v228 offset:0
    v_mfma_f32_16x16x32_bf16 v[44:47], v[88:91], v[128:131], v[44:47]
    ds_read_b64_tr_b16 v[86:87], v228 offset:512
    v_mfma_f32_16x16x32_bf16 v[48:51], v[88:91], v[132:135], v[48:51]
    v_mfma_f32_16x16x32_bf16 v[52:55], v[88:91], v[136:139], v[52:55]
    v_mfma_f32_16x16x32_bf16 v[56:59], v[88:91], v[140:143], v[56:59]
    v_mfma_f32_16x16x32_bf16 v[60:63], v[88:91], v[144:147], v[60:63]
    v_mfma_f32_16x16x32_bf16 v[64:67], v[88:91], v[148:151], v[64:67]
    v_mfma_f32_16x16x32_bf16 v[68:71], v[88:91], v[152:155], v[68:71]
    s_waitcnt lgkmcnt(2)
    v_mfma_f32_16x16x32_bf16 v[36:39], v[80:83], v[124:127], 0
    s_barrier
    v_mfma_f32_16x16x32_bf16 v[40:43], v[80:83], v[128:131], v[40:43]
    ds_read_b64_tr_b16 v[88:89], v228 offset:4096
    v_mfma_f32_16x16x32_bf16 v[44:47], v[80:83], v[132:135], v[44:47]
    ds_read_b64_tr_b16 v[90:91], v228 offset:4608
    v_mfma_f32_16x16x32_bf16 v[48:51], v[80:83], v[136:139], v[48:51]
    ds_read_b128 v[92:95], v220 offset:0
    v_mfma_f32_16x16x32_bf16 v[52:55], v[80:83], v[140:143], v[52:55]
    ds_read_b128 v[96:99], v222 offset:0
    v_mfma_f32_16x16x32_bf16 v[56:59], v[80:83], v[144:147], v[56:59]
    ds_read_b128 v[100:103], v220 offset:256
    v_mfma_f32_16x16x32_bf16 v[60:63], v[80:83], v[148:151], v[60:63]
    ds_read_b128 v[104:107], v222 offset:256
    v_mfma_f32_16x16x32_bf16 v[64:67], v[80:83], v[152:155], v[64:67]
    s_waitcnt lgkmcnt(3)
    v_mfma_f32_16x16x32_bf16 v[16:19], v[84:87], v[92:95], 0
    ds_read_b64_tr_b16 v[80:81], v228 offset:8192
    s_waitcnt lgkmcnt(3)
    v_mfma_f32_16x16x32_bf16 v[20:23], v[84:87], v[96:99], 0
    ds_read_b64_tr_b16 v[82:83], v228 offset:8704
    s_waitcnt lgkmcnt(3)
    v_mfma_f32_16x16x32_bf16 v[24:27], v[84:87], v[100:103], 0
    ds_read_b128 v[108:111], v220 offset:512
    s_waitcnt lgkmcnt(3)
    v_mfma_f32_16x16x32_bf16 v[28:31], v[84:87], v[104:107], 0
    ds_read_b128 v[112:115], v222 offset:512
    s_waitcnt lgkmcnt(1)
    v_mfma_f32_16x16x32_bf16 v[32:35], v[84:87], v[108:111], 0
    ds_read_b128 v[116:119], v220 offset:768
    s_waitcnt lgkmcnt(1)
    v_mfma_f32_16x16x32_bf16 v[36:39], v[84:87], v[112:115], v[36:39]
    ds_read_b128 v[120:123], v222 offset:768
    s_waitcnt lgkmcnt(1)
    v_mfma_f32_16x16x32_bf16 v[40:43], v[84:87], v[116:119], v[40:43]
    ds_read_b128 v[156:159], v224 offset:2048
    s_waitcnt lgkmcnt(1)
    v_mfma_f32_16x16x32_bf16 v[44:47], v[84:87], v[120:123], v[44:47]
    v_mfma_f32_16x16x32_bf16 v[16:19], v[88:91], v[96:99], v[16:19]
    ds_read_b64_tr_b16 v[84:85], v228 offset:12288
    v_mfma_f32_16x16x32_bf16 v[20:23], v[88:91], v[100:103], v[20:23]
    ds_read_b64_tr_b16 v[86:87], v228 offset:12800
    v_mfma_f32_16x16x32_bf16 v[24:27], v[88:91], v[104:107], v[24:27]
    ds_read_b128 v[160:163], v226 offset:2048
    v_mfma_f32_16x16x32_bf16 v[28:31], v[88:91], v[108:111], v[28:31]
    ds_read_b128 v[164:167], v224 offset:2304
    v_mfma_f32_16x16x32_bf16 v[32:35], v[88:91], v[112:115], v[32:35]
    ds_read_b128 v[168:171], v226 offset:2304
    v_mfma_f32_16x16x32_bf16 v[36:39], v[88:91], v[116:119], v[36:39]
    ds_read_b128 v[172:175], v224 offset:2560
    v_mfma_f32_16x16x32_bf16 v[40:43], v[88:91], v[120:123], v[40:43]
    ds_read_b128 v[176:179], v226 offset:2560
    s_waitcnt lgkmcnt(7)
    v_mfma_f32_16x16x32_bf16 v[76:79], v[88:91], v[156:159], v[76:79]
    v_mfma_f32_16x16x32_bf16 v[16:19], v[80:83], v[100:103], v[16:19]
L_PAD1:
    s_cbranch_execz L_PAD9
    ds_read_b128 v[180:183], v224 offset:2816
    v_mfma_f32_16x16x32_bf16 v[20:23], v[80:83], v[104:107], v[20:23]
    ds_read_b128 v[184:187], v226 offset:2816
    v_mfma_f32_16x16x32_bf16 v[24:27], v[80:83], v[108:111], v[24:27]
    ds_read_b128 v[188:191], v224 offset:3072
    v_mfma_f32_16x16x32_bf16 v[28:31], v[80:83], v[112:115], v[28:31]
    ds_read_b128 v[192:195], v226 offset:3072
    v_mfma_f32_16x16x32_bf16 v[32:35], v[80:83], v[116:119], v[32:35]
    ds_read_b128 v[196:199], v224 offset:3328
    v_mfma_f32_16x16x32_bf16 v[36:39], v[80:83], v[120:123], v[36:39]
    ds_read_b128 v[200:203], v226 offset:3328
    v_mfma_f32_16x16x32_bf16 v[72:75], v[80:83], v[156:159], v[72:75]
    ds_read_b128 v[204:207], v224 offset:3584
    s_waitcnt lgkmcnt(11)
    v_mfma_f32_16x16x32_bf16 v[76:79], v[80:83], v[160:163], v[76:79]
    v_mfma_f32_16x16x32_bf16 v[16:19], v[84:87], v[104:107], v[16:19]
    s_barrier
    v_mfma_f32_16x16x32_bf16 v[20:23], v[84:87], v[108:111], v[20:23]
    ds_read_b64_tr_b16 v[88:89], v228 offset:16384
    v_mfma_f32_16x16x32_bf16 v[24:27], v[84:87], v[112:115], v[24:27]
    ds_read_b64_tr_b16 v[90:91], v228 offset:16896
    v_mfma_f32_16x16x32_bf16 v[28:31], v[84:87], v[116:119], v[28:31]
    ds_read_b128 v[208:211], v226 offset:3584
    v_mfma_f32_16x16x32_bf16 v[32:35], v[84:87], v[120:123], v[32:35]
    ds_read_b128 v[212:215], v224 offset:3840
    v_mfma_f32_16x16x32_bf16 v[68:71], v[84:87], v[156:159], v[68:71]
    ds_read_b128 v[216:219], v221 offset:0
    v_mfma_f32_16x16x32_bf16 v[72:75], v[84:87], v[160:163], v[72:75]
    ds_read_b128 v[92:95], v223 offset:0
    s_waitcnt lgkmcnt(15)
    v_mfma_f32_16x16x32_bf16 v[76:79], v[84:87], v[164:167], v[76:79]
    s_waitcnt lgkmcnt(4)
    v_mfma_f32_16x16x32_bf16 v[16:19], v[88:91], v[108:111], v[16:19]
    ds_read_b64_tr_b16 v[80:81], v228 offset:20480
    v_mfma_f32_16x16x32_bf16 v[20:23], v[88:91], v[112:115], v[20:23]
    ds_read_b64_tr_b16 v[82:83], v228 offset:20992
    v_mfma_f32_16x16x32_bf16 v[24:27], v[88:91], v[116:119], v[24:27]
    ds_read_b128 v[96:99], v221 offset:256
    v_mfma_f32_16x16x32_bf16 v[28:31], v[88:91], v[120:123], v[28:31]
    ds_read_b128 v[100:103], v223 offset:256
    v_mfma_f32_16x16x32_bf16 v[32:35], v[88:91], v[124:127], v[32:35]
    ds_read_b128 v[104:107], v221 offset:512
    v_mfma_f32_16x16x32_bf16 v[36:39], v[88:91], v[128:131], v[36:39]
    v_mfma_f32_16x16x32_bf16 v[40:43], v[88:91], v[132:135], v[40:43]
    v_mfma_f32_16x16x32_bf16 v[44:47], v[88:91], v[136:139], v[44:47]
    v_mfma_f32_16x16x32_bf16 v[48:51], v[88:91], v[140:143], v[48:51]
    v_mfma_f32_16x16x32_bf16 v[52:55], v[88:91], v[144:147], v[52:55]
    v_mfma_f32_16x16x32_bf16 v[56:59], v[88:91], v[148:151], v[56:59]
    v_mfma_f32_16x16x32_bf16 v[60:63], v[88:91], v[152:155], v[60:63]
    v_mfma_f32_16x16x32_bf16 v[64:67], v[88:91], v[156:159], v[64:67]
    v_mfma_f32_16x16x32_bf16 v[68:71], v[88:91], v[160:163], v[68:71]
    v_mfma_f32_16x16x32_bf16 v[72:75], v[88:91], v[164:167], v[72:75]
    v_mfma_f32_16x16x32_bf16 v[76:79], v[88:91], v[168:171], v[76:79]
    s_waitcnt lgkmcnt(3)
    v_mfma_f32_16x16x32_bf16 v[16:19], v[80:83], v[112:115], v[16:19]
    s_barrier
    v_mfma_f32_16x16x32_bf16 v[20:23], v[80:83], v[116:119], v[20:23]
    ds_read_b64_tr_b16 v[84:85], v228 offset:24576
    v_mfma_f32_16x16x32_bf16 v[24:27], v[80:83], v[120:123], v[24:27]
    ds_read_b64_tr_b16 v[86:87], v228 offset:25088
    v_mfma_f32_16x16x32_bf16 v[28:31], v[80:83], v[124:127], v[28:31]
    ds_read_b128 v[108:111], v223 offset:512
    v_mfma_f32_16x16x32_bf16 v[32:35], v[80:83], v[128:131], v[32:35]
    v_mfma_f32_16x16x32_bf16 v[36:39], v[80:83], v[132:135], v[36:39]
    v_mfma_f32_16x16x32_bf16 v[40:43], v[80:83], v[136:139], v[40:43]
    v_mfma_f32_16x16x32_bf16 v[44:47], v[80:83], v[140:143], v[44:47]
L_PAD2:
    s_cbranch_execz L_PAD10
    v_mfma_f32_16x16x32_bf16 v[48:51], v[80:83], v[144:147], v[48:51]
    v_mfma_f32_16x16x32_bf16 v[52:55], v[80:83], v[148:151], v[52:55]
    v_mfma_f32_16x16x32_bf16 v[56:59], v[80:83], v[152:155], v[56:59]
    v_mfma_f32_16x16x32_bf16 v[60:63], v[80:83], v[156:159], v[60:63]
    v_mfma_f32_16x16x32_bf16 v[64:67], v[80:83], v[160:163], v[64:67]
    v_mfma_f32_16x16x32_bf16 v[68:71], v[80:83], v[164:167], v[68:71]
    v_mfma_f32_16x16x32_bf16 v[72:75], v[80:83], v[168:171], v[72:75]
    v_mfma_f32_16x16x32_bf16 v[76:79], v[80:83], v[172:175], v[76:79]
    s_waitcnt lgkmcnt(1)
    v_mfma_f32_16x16x32_bf16 v[16:19], v[84:87], v[116:119], v[16:19]
    ds_read_b64_tr_b16 v[88:89], v228 offset:28672
    v_mfma_f32_16x16x32_bf16 v[20:23], v[84:87], v[120:123], v[20:23]
    ds_read_b64_tr_b16 v[90:91], v228 offset:29184
    v_mfma_f32_16x16x32_bf16 v[24:27], v[84:87], v[124:127], v[24:27]
    ds_read_b128 v[112:115], v221 offset:768
    v_mfma_f32_16x16x32_bf16 v[28:31], v[84:87], v[128:131], v[28:31]
    v_mfma_f32_16x16x32_bf16 v[32:35], v[84:87], v[132:135], v[32:35]
    v_mfma_f32_16x16x32_bf16 v[36:39], v[84:87], v[136:139], v[36:39]
    v_mfma_f32_16x16x32_bf16 v[40:43], v[84:87], v[140:143], v[40:43]
    v_mfma_f32_16x16x32_bf16 v[44:47], v[84:87], v[144:147], v[44:47]
    v_mfma_f32_16x16x32_bf16 v[48:51], v[84:87], v[148:151], v[48:51]
    v_mfma_f32_16x16x32_bf16 v[52:55], v[84:87], v[152:155], v[52:55]
    v_mfma_f32_16x16x32_bf16 v[56:59], v[84:87], v[156:159], v[56:59]
    v_mfma_f32_16x16x32_bf16 v[60:63], v[84:87], v[160:163], v[60:63]
    v_mfma_f32_16x16x32_bf16 v[64:67], v[84:87], v[164:167], v[64:67]
    v_mfma_f32_16x16x32_bf16 v[68:71], v[84:87], v[168:171], v[68:71]
    v_mfma_f32_16x16x32_bf16 v[72:75], v[84:87], v[172:175], v[72:75]
    v_mfma_f32_16x16x32_bf16 v[76:79], v[84:87], v[176:179], v[76:79]
    s_waitcnt lgkmcnt(1)
    v_mfma_f32_16x16x32_bf16 v[16:19], v[88:91], v[120:123], v[16:19]
    s_barrier
    v_mfma_f32_16x16x32_bf16 v[20:23], v[88:91], v[124:127], v[20:23]
    ds_read_b64_tr_b16 v[80:81], v228 offset:32768
    v_mfma_f32_16x16x32_bf16 v[24:27], v[88:91], v[128:131], v[24:27]
    ds_read_b64_tr_b16 v[82:83], v228 offset:33280
    v_mfma_f32_16x16x32_bf16 v[28:31], v[88:91], v[132:135], v[28:31]
    ds_read_b128 v[116:119], v223 offset:768
    v_mfma_f32_16x16x32_bf16 v[32:35], v[88:91], v[136:139], v[32:35]
    v_mfma_f32_16x16x32_bf16 v[36:39], v[88:91], v[140:143], v[36:39]
    v_mfma_f32_16x16x32_bf16 v[40:43], v[88:91], v[144:147], v[40:43]
    v_mfma_f32_16x16x32_bf16 v[44:47], v[88:91], v[148:151], v[44:47]
    v_mfma_f32_16x16x32_bf16 v[48:51], v[88:91], v[152:155], v[48:51]
    v_mfma_f32_16x16x32_bf16 v[52:55], v[88:91], v[156:159], v[52:55]
    v_mfma_f32_16x16x32_bf16 v[56:59], v[88:91], v[160:163], v[56:59]
    v_mfma_f32_16x16x32_bf16 v[60:63], v[88:91], v[164:167], v[60:63]
    v_mfma_f32_16x16x32_bf16 v[64:67], v[88:91], v[168:171], v[64:67]
    v_mfma_f32_16x16x32_bf16 v[68:71], v[88:91], v[172:175], v[68:71]
    v_mfma_f32_16x16x32_bf16 v[72:75], v[88:91], v[176:179], v[72:75]
    v_mfma_f32_16x16x32_bf16 v[76:79], v[88:91], v[180:183], v[76:79]
    s_waitcnt lgkmcnt(1)
    v_mfma_f32_16x16x32_bf16 v[16:19], v[80:83], v[124:127], v[16:19]
    ds_read_b64_tr_b16 v[84:85], v228 offset:36864
    v_mfma_f32_16x16x32_bf16 v[20:23], v[80:83], v[128:131], v[20:23]
    ds_read_b64_tr_b16 v[86:87], v228 offset:37376
    v_mfma_f32_16x16x32_bf16 v[24:27], v[80:83], v[132:135], v[24:27]
    ds_read_b128 v[120:123], v221 offset:1024
    v_mfma_f32_16x16x32_bf16 v[28:31], v[80:83], v[136:139], v[28:31]
    v_mfma_f32_16x16x32_bf16 v[32:35], v[80:83], v[140:143], v[32:35]
    v_mfma_f32_16x16x32_bf16 v[36:39], v[80:83], v[144:147], v[36:39]
    v_mfma_f32_16x16x32_bf16 v[40:43], v[80:83], v[148:151], v[40:43]
    v_mfma_f32_16x16x32_bf16 v[44:47], v[80:83], v[152:155], v[44:47]
    v_mfma_f32_16x16x32_bf16 v[48:51], v[80:83], v[156:159], v[48:51]
    v_mfma_f32_16x16x32_bf16 v[52:55], v[80:83], v[160:163], v[52:55]
    v_mfma_f32_16x16x32_bf16 v[56:59], v[80:83], v[164:167], v[56:59]
    v_mfma_f32_16x16x32_bf16 v[60:63], v[80:83], v[168:171], v[60:63]
    v_mfma_f32_16x16x32_bf16 v[64:67], v[80:83], v[172:175], v[64:67]
L_PAD3:
    s_cbranch_execz L_PAD11
    v_mfma_f32_16x16x32_bf16 v[68:71], v[80:83], v[176:179], v[68:71]
    v_mfma_f32_16x16x32_bf16 v[72:75], v[80:83], v[180:183], v[72:75]
    v_mfma_f32_16x16x32_bf16 v[76:79], v[80:83], v[184:187], v[76:79]
    s_waitcnt lgkmcnt(1)
    v_mfma_f32_16x16x32_bf16 v[16:19], v[84:87], v[128:131], v[16:19]
    s_barrier
    v_mfma_f32_16x16x32_bf16 v[20:23], v[84:87], v[132:135], v[20:23]
    ds_read_b64_tr_b16 v[88:89], v228 offset:40960
    v_mfma_f32_16x16x32_bf16 v[24:27], v[84:87], v[136:139], v[24:27]
    ds_read_b64_tr_b16 v[90:91], v228 offset:41472
    v_mfma_f32_16x16x32_bf16 v[28:31], v[84:87], v[140:143], v[28:31]
    ds_read_b128 v[124:127], v223 offset:1024
    v_mfma_f32_16x16x32_bf16 v[32:35], v[84:87], v[144:147], v[32:35]
    v_mfma_f32_16x16x32_bf16 v[36:39], v[84:87], v[148:151], v[36:39]
    v_mfma_f32_16x16x32_bf16 v[40:43], v[84:87], v[152:155], v[40:43]
    v_mfma_f32_16x16x32_bf16 v[44:47], v[84:87], v[156:159], v[44:47]
    v_mfma_f32_16x16x32_bf16 v[48:51], v[84:87], v[160:163], v[48:51]
    v_mfma_f32_16x16x32_bf16 v[52:55], v[84:87], v[164:167], v[52:55]
    v_mfma_f32_16x16x32_bf16 v[56:59], v[84:87], v[168:171], v[56:59]
    v_mfma_f32_16x16x32_bf16 v[60:63], v[84:87], v[172:175], v[60:63]
    v_mfma_f32_16x16x32_bf16 v[64:67], v[84:87], v[176:179], v[64:67]
    v_mfma_f32_16x16x32_bf16 v[68:71], v[84:87], v[180:183], v[68:71]
    v_mfma_f32_16x16x32_bf16 v[72:75], v[84:87], v[184:187], v[72:75]
    v_mfma_f32_16x16x32_bf16 v[76:79], v[84:87], v[188:191], v[76:79]
    s_waitcnt lgkmcnt(1)
    v_mfma_f32_16x16x32_bf16 v[16:19], v[88:91], v[132:135], v[16:19]
    ds_read_b64_tr_b16 v[80:81], v229 offset:0
    v_mfma_f32_16x16x32_bf16 v[20:23], v[88:91], v[136:139], v[20:23]
    ds_read_b64_tr_b16 v[82:83], v229 offset:512
    v_mfma_f32_16x16x32_bf16 v[24:27], v[88:91], v[140:143], v[24:27]
    ds_read_b128 v[128:131], v221 offset:1280
    v_mfma_f32_16x16x32_bf16 v[28:31], v[88:91], v[144:147], v[28:31]
    v_mfma_f32_16x16x32_bf16 v[32:35], v[88:91], v[148:151], v[32:35]
    v_mfma_f32_16x16x32_bf16 v[36:39], v[88:91], v[152:155], v[36:39]
    v_mfma_f32_16x16x32_bf16 v[40:43], v[88:91], v[156:159], v[40:43]
    v_mfma_f32_16x16x32_bf16 v[44:47], v[88:91], v[160:163], v[44:47]
    v_mfma_f32_16x16x32_bf16 v[48:51], v[88:91], v[164:167], v[48:51]
    v_mfma_f32_16x16x32_bf16 v[52:55], v[88:91], v[168:171], v[52:55]
    v_mfma_f32_16x16x32_bf16 v[56:59], v[88:91], v[172:175], v[56:59]
    v_mfma_f32_16x16x32_bf16 v[60:63], v[88:91], v[176:179], v[60:63]
    v_mfma_f32_16x16x32_bf16 v[64:67], v[88:91], v[180:183], v[64:67]
    v_mfma_f32_16x16x32_bf16 v[68:71], v[88:91], v[184:187], v[68:71]
    v_mfma_f32_16x16x32_bf16 v[72:75], v[88:91], v[188:191], v[72:75]
    v_mfma_f32_16x16x32_bf16 v[76:79], v[88:91], v[192:195], v[76:79]
    s_waitcnt lgkmcnt(1)
    v_mfma_f32_16x16x32_bf16 v[16:19], v[80:83], v[136:139], v[16:19]
    s_barrier
    v_mfma_f32_16x16x32_bf16 v[20:23], v[80:83], v[140:143], v[20:23]
    ds_read_b64_tr_b16 v[84:85], v229 offset:4096
    v_mfma_f32_16x16x32_bf16 v[24:27], v[80:83], v[144:147], v[24:27]
    ds_read_b64_tr_b16 v[86:87], v229 offset:4608
    v_mfma_f32_16x16x32_bf16 v[28:31], v[80:83], v[148:151], v[28:31]
    ds_read_b128 v[132:135], v223 offset:1280
    v_mfma_f32_16x16x32_bf16 v[32:35], v[80:83], v[152:155], v[32:35]
    v_mfma_f32_16x16x32_bf16 v[36:39], v[80:83], v[156:159], v[36:39]
    v_mfma_f32_16x16x32_bf16 v[40:43], v[80:83], v[160:163], v[40:43]
    v_mfma_f32_16x16x32_bf16 v[44:47], v[80:83], v[164:167], v[44:47]
    v_mfma_f32_16x16x32_bf16 v[48:51], v[80:83], v[168:171], v[48:51]
    v_mfma_f32_16x16x32_bf16 v[52:55], v[80:83], v[172:175], v[52:55]
    v_mfma_f32_16x16x32_bf16 v[56:59], v[80:83], v[176:179], v[56:59]
    v_mfma_f32_16x16x32_bf16 v[60:63], v[80:83], v[180:183], v[60:63]
    v_mfma_f32_16x16x32_bf16 v[64:67], v[80:83], v[184:187], v[64:67]
    v_mfma_f32_16x16x32_bf16 v[68:71], v[80:83], v[188:191], v[68:71]
    v_mfma_f32_16x16x32_bf16 v[72:75], v[80:83], v[192:195], v[72:75]
    v_mfma_f32_16x16x32_bf16 v[76:79], v[80:83], v[196:199], v[76:79]
    s_waitcnt lgkmcnt(1)
L_PAD4:
    s_cbranch_execz L_PAD12
    v_mfma_f32_16x16x32_bf16 v[16:19], v[84:87], v[140:143], v[16:19]
    ds_read_b64_tr_b16 v[88:89], v229 offset:8192
    v_mfma_f32_16x16x32_bf16 v[20:23], v[84:87], v[144:147], v[20:23]
    ds_read_b64_tr_b16 v[90:91], v229 offset:8704
    v_mfma_f32_16x16x32_bf16 v[24:27], v[84:87], v[148:151], v[24:27]
    ds_read_b128 v[136:139], v221 offset:1536
    v_mfma_f32_16x16x32_bf16 v[28:31], v[84:87], v[152:155], v[28:31]
    v_mfma_f32_16x16x32_bf16 v[32:35], v[84:87], v[156:159], v[32:35]
    v_mfma_f32_16x16x32_bf16 v[36:39], v[84:87], v[160:163], v[36:39]
    v_mfma_f32_16x16x32_bf16 v[40:43], v[84:87], v[164:167], v[40:43]
    v_mfma_f32_16x16x32_bf16 v[44:47], v[84:87], v[168:171], v[44:47]
    v_mfma_f32_16x16x32_bf16 v[48:51], v[84:87], v[172:175], v[48:51]
    v_mfma_f32_16x16x32_bf16 v[52:55], v[84:87], v[176:179], v[52:55]
    v_mfma_f32_16x16x32_bf16 v[56:59], v[84:87], v[180:183], v[56:59]
    v_mfma_f32_16x16x32_bf16 v[60:63], v[84:87], v[184:187], v[60:63]
    v_mfma_f32_16x16x32_bf16 v[64:67], v[84:87], v[188:191], v[64:67]
    v_mfma_f32_16x16x32_bf16 v[68:71], v[84:87], v[192:195], v[68:71]
    v_mfma_f32_16x16x32_bf16 v[72:75], v[84:87], v[196:199], v[72:75]
    v_mfma_f32_16x16x32_bf16 v[76:79], v[84:87], v[200:203], v[76:79]
    s_waitcnt lgkmcnt(1)
    v_mfma_f32_16x16x32_bf16 v[16:19], v[88:91], v[144:147], v[16:19]
    s_barrier
    v_mfma_f32_16x16x32_bf16 v[20:23], v[88:91], v[148:151], v[20:23]
    ds_read_b64_tr_b16 v[80:81], v229 offset:12288
    v_mfma_f32_16x16x32_bf16 v[24:27], v[88:91], v[152:155], v[24:27]
    ds_read_b64_tr_b16 v[82:83], v229 offset:12800
    v_mfma_f32_16x16x32_bf16 v[28:31], v[88:91], v[156:159], v[28:31]
    ds_read_b128 v[140:143], v223 offset:1536
    v_mfma_f32_16x16x32_bf16 v[32:35], v[88:91], v[160:163], v[32:35]
    v_mfma_f32_16x16x32_bf16 v[36:39], v[88:91], v[164:167], v[36:39]
    v_mfma_f32_16x16x32_bf16 v[40:43], v[88:91], v[168:171], v[40:43]
    v_mfma_f32_16x16x32_bf16 v[44:47], v[88:91], v[172:175], v[44:47]
    v_mfma_f32_16x16x32_bf16 v[48:51], v[88:91], v[176:179], v[48:51]
    v_mfma_f32_16x16x32_bf16 v[52:55], v[88:91], v[180:183], v[52:55]
    v_mfma_f32_16x16x32_bf16 v[56:59], v[88:91], v[184:187], v[56:59]
    v_mfma_f32_16x16x32_bf16 v[60:63], v[88:91], v[188:191], v[60:63]
    v_mfma_f32_16x16x32_bf16 v[64:67], v[88:91], v[192:195], v[64:67]
    v_mfma_f32_16x16x32_bf16 v[68:71], v[88:91], v[196:199], v[68:71]
    v_mfma_f32_16x16x32_bf16 v[72:75], v[88:91], v[200:203], v[72:75]
    v_mfma_f32_16x16x32_bf16 v[76:79], v[88:91], v[204:207], v[76:79]
    s_waitcnt lgkmcnt(1)
    v_mfma_f32_16x16x32_bf16 v[16:19], v[80:83], v[148:151], v[16:19]
    ds_read_b64_tr_b16 v[84:85], v229 offset:16384
    v_mfma_f32_16x16x32_bf16 v[20:23], v[80:83], v[152:155], v[20:23]
    ds_read_b64_tr_b16 v[86:87], v229 offset:16896
    v_mfma_f32_16x16x32_bf16 v[24:27], v[80:83], v[156:159], v[24:27]
    ds_read_b128 v[144:147], v221 offset:1792
    v_mfma_f32_16x16x32_bf16 v[28:31], v[80:83], v[160:163], v[28:31]
    v_mfma_f32_16x16x32_bf16 v[32:35], v[80:83], v[164:167], v[32:35]
    v_mfma_f32_16x16x32_bf16 v[36:39], v[80:83], v[168:171], v[36:39]
    v_mfma_f32_16x16x32_bf16 v[40:43], v[80:83], v[172:175], v[40:43]
    v_mfma_f32_16x16x32_bf16 v[44:47], v[80:83], v[176:179], v[44:47]
    v_mfma_f32_16x16x32_bf16 v[48:51], v[80:83], v[180:183], v[48:51]
    v_mfma_f32_16x16x32_bf16 v[52:55], v[80:83], v[184:187], v[52:55]
    v_mfma_f32_16x16x32_bf16 v[56:59], v[80:83], v[188:191], v[56:59]
    v_mfma_f32_16x16x32_bf16 v[60:63], v[80:83], v[192:195], v[60:63]
    v_mfma_f32_16x16x32_bf16 v[64:67], v[80:83], v[196:199], v[64:67]
    v_mfma_f32_16x16x32_bf16 v[68:71], v[80:83], v[200:203], v[68:71]
    v_mfma_f32_16x16x32_bf16 v[72:75], v[80:83], v[204:207], v[72:75]
    v_mfma_f32_16x16x32_bf16 v[76:79], v[80:83], v[208:211], v[76:79]
    s_waitcnt lgkmcnt(1)
    v_mfma_f32_16x16x32_bf16 v[16:19], v[84:87], v[152:155], v[16:19]
    s_barrier
    v_mfma_f32_16x16x32_bf16 v[20:23], v[84:87], v[156:159], v[20:23]
    ds_read_b64_tr_b16 v[88:89], v229 offset:20480
    v_mfma_f32_16x16x32_bf16 v[24:27], v[84:87], v[160:163], v[24:27]
L_PAD5:
    s_cbranch_execz L_PAD13
    ds_read_b64_tr_b16 v[90:91], v229 offset:20992
    v_mfma_f32_16x16x32_bf16 v[28:31], v[84:87], v[164:167], v[28:31]
    ds_read_b128 v[148:151], v223 offset:1792
    v_mfma_f32_16x16x32_bf16 v[32:35], v[84:87], v[168:171], v[32:35]
    v_mfma_f32_16x16x32_bf16 v[36:39], v[84:87], v[172:175], v[36:39]
    v_mfma_f32_16x16x32_bf16 v[40:43], v[84:87], v[176:179], v[40:43]
    v_mfma_f32_16x16x32_bf16 v[44:47], v[84:87], v[180:183], v[44:47]
    v_mfma_f32_16x16x32_bf16 v[48:51], v[84:87], v[184:187], v[48:51]
    v_mfma_f32_16x16x32_bf16 v[52:55], v[84:87], v[188:191], v[52:55]
    v_mfma_f32_16x16x32_bf16 v[56:59], v[84:87], v[192:195], v[56:59]
    v_mfma_f32_16x16x32_bf16 v[60:63], v[84:87], v[196:199], v[60:63]
    v_mfma_f32_16x16x32_bf16 v[64:67], v[84:87], v[200:203], v[64:67]
    v_mfma_f32_16x16x32_bf16 v[68:71], v[84:87], v[204:207], v[68:71]
    v_mfma_f32_16x16x32_bf16 v[72:75], v[84:87], v[208:211], v[72:75]
    v_mfma_f32_16x16x32_bf16 v[76:79], v[84:87], v[212:215], v[76:79]
    s_waitcnt lgkmcnt(1)
    v_mfma_f32_16x16x32_bf16 v[16:19], v[88:91], v[216:219], v[16:19]
    ds_read_b64_tr_b16 v[80:81], v229 offset:24576
    v_mfma_f32_16x16x32_bf16 v[20:23], v[88:91], v[92:95], v[20:23]
    ds_read_b64_tr_b16 v[82:83], v229 offset:25088
    v_mfma_f32_16x16x32_bf16 v[24:27], v[88:91], v[96:99], v[24:27]
    ds_read_b128 v[152:155], v225 offset:2048
    v_mfma_f32_16x16x32_bf16 v[28:31], v[88:91], v[100:103], v[28:31]
    ds_read_b128 v[156:159], v227 offset:2048
    v_mfma_f32_16x16x32_bf16 v[32:35], v[88:91], v[104:107], v[32:35]
    ds_read_b128 v[160:163], v225 offset:2304
    v_mfma_f32_16x16x32_bf16 v[36:39], v[88:91], v[108:111], v[36:39]
    ds_read_b128 v[164:167], v227 offset:2304
    v_mfma_f32_16x16x32_bf16 v[40:43], v[88:91], v[112:115], v[40:43]
    v_mfma_f32_16x16x32_bf16 v[44:47], v[88:91], v[116:119], v[44:47]
    s_waitcnt lgkmcnt(6)
    v_mfma_f32_16x16x32_bf16 v[48:51], v[88:91], v[120:123], v[48:51]
    v_mfma_f32_16x16x32_bf16 v[52:55], v[88:91], v[124:127], v[52:55]
    v_mfma_f32_16x16x32_bf16 v[56:59], v[88:91], v[128:131], v[56:59]
    v_mfma_f32_16x16x32_bf16 v[60:63], v[88:91], v[132:135], v[60:63]
    v_mfma_f32_16x16x32_bf16 v[64:67], v[88:91], v[136:139], v[64:67]
    v_mfma_f32_16x16x32_bf16 v[68:71], v[88:91], v[140:143], v[68:71]
    v_mfma_f32_16x16x32_bf16 v[72:75], v[88:91], v[144:147], v[72:75]
    v_mfma_f32_16x16x32_bf16 v[76:79], v[88:91], v[148:151], v[76:79]
    s_waitcnt lgkmcnt(4)
    v_mfma_f32_16x16x32_bf16 v[16:19], v[80:83], v[92:95], v[16:19]
    s_barrier
    v_mfma_f32_16x16x32_bf16 v[20:23], v[80:83], v[96:99], v[20:23]
    ds_read_b64_tr_b16 v[84:85], v229 offset:28672
    v_mfma_f32_16x16x32_bf16 v[24:27], v[80:83], v[100:103], v[24:27]
    ds_read_b64_tr_b16 v[86:87], v229 offset:29184
    v_mfma_f32_16x16x32_bf16 v[28:31], v[80:83], v[104:107], v[28:31]
    ds_read_b128 v[168:171], v225 offset:2560
    v_mfma_f32_16x16x32_bf16 v[32:35], v[80:83], v[108:111], v[32:35]
    ds_read_b128 v[172:175], v227 offset:2560
    v_mfma_f32_16x16x32_bf16 v[36:39], v[80:83], v[112:115], v[36:39]
    ds_read_b128 v[176:179], v225 offset:2816
    v_mfma_f32_16x16x32_bf16 v[40:43], v[80:83], v[116:119], v[40:43]
    ds_read_b128 v[180:183], v227 offset:2816
    v_mfma_f32_16x16x32_bf16 v[44:47], v[80:83], v[120:123], v[44:47]
    s_waitcnt lgkmcnt(9)
    v_mfma_f32_16x16x32_bf16 v[48:51], v[80:83], v[124:127], v[48:51]
    v_mfma_f32_16x16x32_bf16 v[52:55], v[80:83], v[128:131], v[52:55]
    v_mfma_f32_16x16x32_bf16 v[56:59], v[80:83], v[132:135], v[56:59]
    v_mfma_f32_16x16x32_bf16 v[60:63], v[80:83], v[136:139], v[60:63]
    v_mfma_f32_16x16x32_bf16 v[64:67], v[80:83], v[140:143], v[64:67]
    v_mfma_f32_16x16x32_bf16 v[68:71], v[80:83], v[144:147], v[68:71]
    v_mfma_f32_16x16x32_bf16 v[72:75], v[80:83], v[148:151], v[72:75]
    v_mfma_f32_16x16x32_bf16 v[76:79], v[80:83], v[152:155], v[76:79]
    s_waitcnt lgkmcnt(4)
    v_mfma_f32_16x16x32_bf16 v[16:19], v[84:87], v[96:99], v[16:19]
    ds_read_b64_tr_b16 v[88:89], v229 offset:32768
L_PAD6:
    s_cbranch_execz L_PAD14
    v_mfma_f32_16x16x32_bf16 v[20:23], v[84:87], v[100:103], v[20:23]
    ds_read_b64_tr_b16 v[90:91], v229 offset:33280
    v_mfma_f32_16x16x32_bf16 v[24:27], v[84:87], v[104:107], v[24:27]
    ds_read_b128 v[184:187], v225 offset:3072
    v_mfma_f32_16x16x32_bf16 v[28:31], v[84:87], v[108:111], v[28:31]
    ds_read_b128 v[188:191], v227 offset:3072
    v_mfma_f32_16x16x32_bf16 v[32:35], v[84:87], v[112:115], v[32:35]
    ds_read_b128 v[192:195], v225 offset:3328
    v_mfma_f32_16x16x32_bf16 v[36:39], v[84:87], v[116:119], v[36:39]
    ds_read_b128 v[196:199], v227 offset:3328
    v_mfma_f32_16x16x32_bf16 v[40:43], v[84:87], v[120:123], v[40:43]
    v_mfma_f32_16x16x32_bf16 v[44:47], v[84:87], v[124:127], v[44:47]
    v_mfma_f32_16x16x32_bf16 v[48:51], v[84:87], v[128:131], v[48:51]
    v_mfma_f32_16x16x32_bf16 v[52:55], v[84:87], v[132:135], v[52:55]
    v_mfma_f32_16x16x32_bf16 v[56:59], v[84:87], v[136:139], v[56:59]
    v_mfma_f32_16x16x32_bf16 v[60:63], v[84:87], v[140:143], v[60:63]
    v_mfma_f32_16x16x32_bf16 v[64:67], v[84:87], v[144:147], v[64:67]
    v_mfma_f32_16x16x32_bf16 v[68:71], v[84:87], v[148:151], v[68:71]
    v_mfma_f32_16x16x32_bf16 v[72:75], v[84:87], v[152:155], v[72:75]
    v_mfma_f32_16x16x32_bf16 v[76:79], v[84:87], v[156:159], v[76:79]
    s_waitcnt lgkmcnt(4)
    v_mfma_f32_16x16x32_bf16 v[16:19], v[88:91], v[100:103], v[16:19]
    s_barrier
    v_mfma_f32_16x16x32_bf16 v[20:23], v[88:91], v[104:107], v[20:23]
    ds_read_b64_tr_b16 v[80:81], v229 offset:36864
    v_mfma_f32_16x16x32_bf16 v[24:27], v[88:91], v[108:111], v[24:27]
    ds_read_b64_tr_b16 v[82:83], v229 offset:37376
    v_mfma_f32_16x16x32_bf16 v[28:31], v[88:91], v[112:115], v[28:31]
    ds_read_b128 v[200:203], v225 offset:3584
    v_mfma_f32_16x16x32_bf16 v[32:35], v[88:91], v[116:119], v[32:35]
    ds_read_b128 v[204:207], v227 offset:3584
    v_mfma_f32_16x16x32_bf16 v[36:39], v[88:91], v[120:123], v[36:39]
    ds_read_b128 v[208:211], v225 offset:3840
    v_mfma_f32_16x16x32_bf16 v[40:43], v[88:91], v[124:127], v[40:43]
    v_mfma_f32_16x16x32_bf16 v[44:47], v[88:91], v[128:131], v[44:47]
    v_mfma_f32_16x16x32_bf16 v[48:51], v[88:91], v[132:135], v[48:51]
    v_mfma_f32_16x16x32_bf16 v[52:55], v[88:91], v[136:139], v[52:55]
    v_mfma_f32_16x16x32_bf16 v[56:59], v[88:91], v[140:143], v[56:59]
    v_mfma_f32_16x16x32_bf16 v[60:63], v[88:91], v[144:147], v[60:63]
    v_mfma_f32_16x16x32_bf16 v[64:67], v[88:91], v[148:151], v[64:67]
    v_mfma_f32_16x16x32_bf16 v[68:71], v[88:91], v[152:155], v[68:71]
    v_mfma_f32_16x16x32_bf16 v[72:75], v[88:91], v[156:159], v[72:75]
    v_mfma_f32_16x16x32_bf16 v[76:79], v[88:91], v[160:163], v[76:79]
    s_waitcnt lgkmcnt(3)
    v_mfma_f32_16x16x32_bf16 v[16:19], v[80:83], v[104:107], v[16:19]
    ds_read_b64_tr_b16 v[84:85], v229 offset:40960
    v_mfma_f32_16x16x32_bf16 v[20:23], v[80:83], v[108:111], v[20:23]
    ds_read_b64_tr_b16 v[86:87], v229 offset:41472
    v_mfma_f32_16x16x32_bf16 v[24:27], v[80:83], v[112:115], v[24:27]
    v_mfma_f32_16x16x32_bf16 v[28:31], v[80:83], v[116:119], v[28:31]
    v_mfma_f32_16x16x32_bf16 v[32:35], v[80:83], v[120:123], v[32:35]
    v_mfma_f32_16x16x32_bf16 v[36:39], v[80:83], v[124:127], v[36:39]
    v_mfma_f32_16x16x32_bf16 v[40:43], v[80:83], v[128:131], v[40:43]
    v_mfma_f32_16x16x32_bf16 v[44:47], v[80:83], v[132:135], v[44:47]
    v_mfma_f32_16x16x32_bf16 v[48:51], v[80:83], v[136:139], v[48:51]
    v_mfma_f32_16x16x32_bf16 v[52:55], v[80:83], v[140:143], v[52:55]
    v_mfma_f32_16x16x32_bf16 v[56:59], v[80:83], v[144:147], v[56:59]
    v_mfma_f32_16x16x32_bf16 v[60:63], v[80:83], v[148:151], v[60:63]
    v_mfma_f32_16x16x32_bf16 v[64:67], v[80:83], v[152:155], v[64:67]
    v_mfma_f32_16x16x32_bf16 v[68:71], v[80:83], v[156:159], v[68:71]
    v_mfma_f32_16x16x32_bf16 v[72:75], v[80:83], v[160:163], v[72:75]
    v_mfma_f32_16x16x32_bf16 v[76:79], v[80:83], v[164:167], v[76:79]
    s_waitcnt lgkmcnt(0)
    v_mfma_f32_16x16x32_bf16 v[16:19], v[84:87], v[108:111], v[16:19]
    s_barrier
    v_mfma_f32_16x16x32_bf16 v[20:23], v[84:87], v[112:115], v[20:23]
L_PAD7:
    s_cbranch_execz L_PAD15
    ds_read_b64_tr_b16 v[88:89], v228 offset:0
    v_mfma_f32_16x16x32_bf16 v[24:27], v[84:87], v[116:119], v[24:27]
    ds_read_b64_tr_b16 v[90:91], v228 offset:512
    v_mfma_f32_16x16x32_bf16 v[28:31], v[84:87], v[120:123], v[28:31]
    v_mfma_f32_16x16x32_bf16 v[32:35], v[84:87], v[124:127], v[32:35]
    v_mfma_f32_16x16x32_bf16 v[36:39], v[84:87], v[128:131], v[36:39]
    v_mfma_f32_16x16x32_bf16 v[40:43], v[84:87], v[132:135], v[40:43]
    v_mfma_f32_16x16x32_bf16 v[44:47], v[84:87], v[136:139], v[44:47]
    v_mfma_f32_16x16x32_bf16 v[48:51], v[84:87], v[140:143], v[48:51]
    v_mfma_f32_16x16x32_bf16 v[52:55], v[84:87], v[144:147], v[52:55]
    v_mfma_f32_16x16x32_bf16 v[56:59], v[84:87], v[148:151], v[56:59]
    v_mfma_f32_16x16x32_bf16 v[60:63], v[84:87], v[152:155], v[60:63]
    v_mfma_f32_16x16x32_bf16 v[64:67], v[84:87], v[156:159], v[64:67]
    v_mfma_f32_16x16x32_bf16 v[68:71], v[84:87], v[160:163], v[68:71]
    v_mfma_f32_16x16x32_bf16 v[72:75], v[84:87], v[164:167], v[72:75]
    v_mfma_f32_16x16x32_bf16 v[76:79], v[84:87], v[168:171], v[76:79]
    s_waitcnt lgkmcnt(0)
    v_mfma_f32_16x16x32_bf16 v[16:19], v[88:91], v[112:115], v[16:19]
    ds_read_b64_tr_b16 v[80:81], v228 offset:4096
    v_mfma_f32_16x16x32_bf16 v[20:23], v[88:91], v[116:119], v[20:23]
    ds_read_b64_tr_b16 v[82:83], v228 offset:4608
    v_mfma_f32_16x16x32_bf16 v[24:27], v[88:91], v[120:123], v[24:27]
    v_mfma_f32_16x16x32_bf16 v[28:31], v[88:91], v[124:127], v[28:31]
    v_mfma_f32_16x16x32_bf16 v[32:35], v[88:91], v[128:131], v[32:35]
    v_mfma_f32_16x16x32_bf16 v[36:39], v[88:91], v[132:135], v[36:39]
    v_mfma_f32_16x16x32_bf16 v[40:43], v[88:91], v[136:139], v[40:43]
    v_mfma_f32_16x16x32_bf16 v[44:47], v[88:91], v[140:143], v[44:47]
    v_mfma_f32_16x16x32_bf16 v[48:51], v[88:91], v[144:147], v[48:51]
    v_mfma_f32_16x16x32_bf16 v[52:55], v[88:91], v[148:151], v[52:55]
    v_mfma_f32_16x16x32_bf16 v[56:59], v[88:91], v[152:155], v[56:59]
    v_mfma_f32_16x16x32_bf16 v[60:63], v[88:91], v[156:159], v[60:63]
    v_mfma_f32_16x16x32_bf16 v[64:67], v[88:91], v[160:163], v[64:67]
    v_mfma_f32_16x16x32_bf16 v[68:71], v[88:91], v[164:167], v[68:71]
    v_mfma_f32_16x16x32_bf16 v[72:75], v[88:91], v[168:171], v[72:75]
    v_mfma_f32_16x16x32_bf16 v[76:79], v[88:91], v[172:175], v[76:79]
    s_waitcnt lgkmcnt(0)
    v_mfma_f32_16x16x32_bf16 v[16:19], v[80:83], v[116:119], v[16:19]
    s_barrier
    v_mfma_f32_16x16x32_bf16 v[20:23], v[80:83], v[120:123], v[20:23]
    ds_read_b64_tr_b16 v[84:85], v228 offset:8192
    v_mfma_f32_16x16x32_bf16 v[24:27], v[80:83], v[124:127], v[24:27]
    ds_read_b64_tr_b16 v[86:87], v228 offset:8704
    v_mfma_f32_16x16x32_bf16 v[28:31], v[80:83], v[128:131], v[28:31]
    v_mfma_f32_16x16x32_bf16 v[32:35], v[80:83], v[132:135], v[32:35]
    v_mfma_f32_16x16x32_bf16 v[36:39], v[80:83], v[136:139], v[36:39]
    v_mfma_f32_16x16x32_bf16 v[40:43], v[80:83], v[140:143], v[40:43]
    v_mfma_f32_16x16x32_bf16 v[44:47], v[80:83], v[144:147], v[44:47]
    v_mfma_f32_16x16x32_bf16 v[48:51], v[80:83], v[148:151], v[48:51]
    v_mfma_f32_16x16x32_bf16 v[52:55], v[80:83], v[152:155], v[52:55]
    v_mfma_f32_16x16x32_bf16 v[56:59], v[80:83], v[156:159], v[56:59]
    v_mfma_f32_16x16x32_bf16 v[60:63], v[80:83], v[160:163], v[60:63]
    v_mfma_f32_16x16x32_bf16 v[64:67], v[80:83], v[164:167], v[64:67]
    v_mfma_f32_16x16x32_bf16 v[68:71], v[80:83], v[168:171], v[68:71]
    v_mfma_f32_16x16x32_bf16 v[72:75], v[80:83], v[172:175], v[72:75]
    v_mfma_f32_16x16x32_bf16 v[76:79], v[80:83], v[176:179], v[76:79]
    s_waitcnt lgkmcnt(0)
    v_mfma_f32_16x16x32_bf16 v[16:19], v[84:87], v[120:123], v[16:19]
    ds_read_b64_tr_b16 v[88:89], v228 offset:12288
    v_mfma_f32_16x16x32_bf16 v[20:23], v[84:87], v[124:127], v[20:23]
    ds_read_b64_tr_b16 v[90:91], v228 offset:12800
    v_mfma_f32_16x16x32_bf16 v[24:27], v[84:87], v[128:131], v[24:27]
    v_mfma_f32_16x16x32_bf16 v[28:31], v[84:87], v[132:135], v[28:31]
    v_mfma_f32_16x16x32_bf16 v[32:35], v[84:87], v[136:139], v[32:35]
    v_mfma_f32_16x16x32_bf16 v[36:39], v[84:87], v[140:143], v[36:39]
    v_mfma_f32_16x16x32_bf16 v[40:43], v[84:87], v[144:147], v[40:43]
L_PAD8:
    s_cbranch_execz L_PAD16
    v_mfma_f32_16x16x32_bf16 v[44:47], v[84:87], v[148:151], v[44:47]
    v_mfma_f32_16x16x32_bf16 v[48:51], v[84:87], v[152:155], v[48:51]
    v_mfma_f32_16x16x32_bf16 v[52:55], v[84:87], v[156:159], v[52:55]
    v_mfma_f32_16x16x32_bf16 v[56:59], v[84:87], v[160:163], v[56:59]
    v_mfma_f32_16x16x32_bf16 v[60:63], v[84:87], v[164:167], v[60:63]
    v_mfma_f32_16x16x32_bf16 v[64:67], v[84:87], v[168:171], v[64:67]
    v_mfma_f32_16x16x32_bf16 v[68:71], v[84:87], v[172:175], v[68:71]
    v_mfma_f32_16x16x32_bf16 v[72:75], v[84:87], v[176:179], v[72:75]
    v_mfma_f32_16x16x32_bf16 v[76:79], v[84:87], v[180:183], v[76:79]
    s_waitcnt lgkmcnt(0)
    v_mfma_f32_16x16x32_bf16 v[16:19], v[88:91], v[124:127], v[16:19]
    s_barrier
    v_mfma_f32_16x16x32_bf16 v[20:23], v[88:91], v[128:131], v[20:23]
    ds_read_b64_tr_b16 v[80:81], v228 offset:16384
    v_mfma_f32_16x16x32_bf16 v[24:27], v[88:91], v[132:135], v[24:27]
    ds_read_b64_tr_b16 v[82:83], v228 offset:16896
    v_mfma_f32_16x16x32_bf16 v[28:31], v[88:91], v[136:139], v[28:31]
    ds_read_b128 v[212:215], v220 offset:34816
    v_mfma_f32_16x16x32_bf16 v[32:35], v[88:91], v[140:143], v[32:35]
    ds_read_b128 v[216:219], v222 offset:34816
    v_mfma_f32_16x16x32_bf16 v[36:39], v[88:91], v[144:147], v[36:39]
    ds_read_b128 v[92:95], v220 offset:35072
    v_mfma_f32_16x16x32_bf16 v[40:43], v[88:91], v[148:151], v[40:43]
    ds_read_b128 v[96:99], v222 offset:35072
    v_mfma_f32_16x16x32_bf16 v[44:47], v[88:91], v[152:155], v[44:47]
    v_mfma_f32_16x16x32_bf16 v[48:51], v[88:91], v[156:159], v[48:51]
    v_mfma_f32_16x16x32_bf16 v[52:55], v[88:91], v[160:163], v[52:55]
    v_mfma_f32_16x16x32_bf16 v[56:59], v[88:91], v[164:167], v[56:59]
    v_mfma_f32_16x16x32_bf16 v[60:63], v[88:91], v[168:171], v[60:63]
    v_mfma_f32_16x16x32_bf16 v[64:67], v[88:91], v[172:175], v[64:67]
    v_mfma_f32_16x16x32_bf16 v[68:71], v[88:91], v[176:179], v[68:71]
    v_mfma_f32_16x16x32_bf16 v[72:75], v[88:91], v[180:183], v[72:75]
    v_mfma_f32_16x16x32_bf16 v[76:79], v[88:91], v[184:187], v[76:79]
    s_waitcnt lgkmcnt(4)
    v_mfma_f32_16x16x32_bf16 v[16:19], v[80:83], v[128:131], v[16:19]
    ds_read_b64_tr_b16 v[84:85], v228 offset:20480
    v_mfma_f32_16x16x32_bf16 v[20:23], v[80:83], v[132:135], v[20:23]
    ds_read_b64_tr_b16 v[86:87], v228 offset:20992
    v_mfma_f32_16x16x32_bf16 v[24:27], v[80:83], v[136:139], v[24:27]
    ds_read_b128 v[100:103], v220 offset:35328
    v_mfma_f32_16x16x32_bf16 v[28:31], v[80:83], v[140:143], v[28:31]
    ds_read_b128 v[104:107], v222 offset:35328
    v_mfma_f32_16x16x32_bf16 v[32:35], v[80:83], v[144:147], v[32:35]
    ds_read_b128 v[108:111], v220 offset:35584
    v_mfma_f32_16x16x32_bf16 v[36:39], v[80:83], v[148:151], v[36:39]
    ds_read_b128 v[112:115], v222 offset:35584
    v_mfma_f32_16x16x32_bf16 v[40:43], v[80:83], v[152:155], v[40:43]
    v_mfma_f32_16x16x32_bf16 v[44:47], v[80:83], v[156:159], v[44:47]
    v_mfma_f32_16x16x32_bf16 v[48:51], v[80:83], v[160:163], v[48:51]
    v_mfma_f32_16x16x32_bf16 v[52:55], v[80:83], v[164:167], v[52:55]
    v_mfma_f32_16x16x32_bf16 v[56:59], v[80:83], v[168:171], v[56:59]
    v_mfma_f32_16x16x32_bf16 v[60:63], v[80:83], v[172:175], v[60:63]
    v_mfma_f32_16x16x32_bf16 v[64:67], v[80:83], v[176:179], v[64:67]
    v_mfma_f32_16x16x32_bf16 v[68:71], v[80:83], v[180:183], v[68:71]
    v_mfma_f32_16x16x32_bf16 v[72:75], v[80:83], v[184:187], v[72:75]
    v_mfma_f32_16x16x32_bf16 v[76:79], v[80:83], v[188:191], v[76:79]
    s_waitcnt lgkmcnt(4)
    v_mfma_f32_16x16x32_bf16 v[16:19], v[84:87], v[132:135], v[16:19]
    s_barrier
    v_mfma_f32_16x16x32_bf16 v[20:23], v[84:87], v[136:139], v[20:23]
    ds_read_b64_tr_b16 v[88:89], v228 offset:24576
    v_mfma_f32_16x16x32_bf16 v[24:27], v[84:87], v[140:143], v[24:27]
    ds_read_b64_tr_b16 v[90:91], v228 offset:25088
    v_mfma_f32_16x16x32_bf16 v[28:31], v[84:87], v[144:147], v[28:31]
    ds_read_b128 v[116:119], v220 offset:35840
    v_mfma_f32_16x16x32_bf16 v[32:35], v[84:87], v[148:151], v[32:35]
L_PAD9:
    s_cbranch_execz L_PAD17
    ds_read_b128 v[120:123], v222 offset:35840
    v_mfma_f32_16x16x32_bf16 v[36:39], v[84:87], v[152:155], v[36:39]
    ds_read_b128 v[124:127], v220 offset:36096
    v_mfma_f32_16x16x32_bf16 v[40:43], v[84:87], v[156:159], v[40:43]
    ds_read_b128 v[128:131], v222 offset:36096
    v_mfma_f32_16x16x32_bf16 v[44:47], v[84:87], v[160:163], v[44:47]
    v_mfma_f32_16x16x32_bf16 v[48:51], v[84:87], v[164:167], v[48:51]
    v_mfma_f32_16x16x32_bf16 v[52:55], v[84:87], v[168:171], v[52:55]
    v_mfma_f32_16x16x32_bf16 v[56:59], v[84:87], v[172:175], v[56:59]
    v_mfma_f32_16x16x32_bf16 v[60:63], v[84:87], v[176:179], v[60:63]
    v_mfma_f32_16x16x32_bf16 v[64:67], v[84:87], v[180:183], v[64:67]
    v_mfma_f32_16x16x32_bf16 v[68:71], v[84:87], v[184:187], v[68:71]
    v_mfma_f32_16x16x32_bf16 v[72:75], v[84:87], v[188:191], v[72:75]
    v_mfma_f32_16x16x32_bf16 v[76:79], v[84:87], v[192:195], v[76:79]
    s_waitcnt lgkmcnt(4)
    v_mfma_f32_16x16x32_bf16 v[16:19], v[88:91], v[136:139], v[16:19]
    ds_read_b64_tr_b16 v[80:81], v228 offset:28672
    v_mfma_f32_16x16x32_bf16 v[20:23], v[88:91], v[140:143], v[20:23]
    ds_read_b64_tr_b16 v[82:83], v228 offset:29184
    v_mfma_f32_16x16x32_bf16 v[24:27], v[88:91], v[144:147], v[24:27]
    ds_read_b128 v[132:135], v220 offset:36352
    v_mfma_f32_16x16x32_bf16 v[28:31], v[88:91], v[148:151], v[28:31]
    v_mfma_f32_16x16x32_bf16 v[32:35], v[88:91], v[152:155], v[32:35]
    v_mfma_f32_16x16x32_bf16 v[36:39], v[88:91], v[156:159], v[36:39]
    v_mfma_f32_16x16x32_bf16 v[40:43], v[88:91], v[160:163], v[40:43]
    v_mfma_f32_16x16x32_bf16 v[44:47], v[88:91], v[164:167], v[44:47]
    v_mfma_f32_16x16x32_bf16 v[48:51], v[88:91], v[168:171], v[48:51]
    v_mfma_f32_16x16x32_bf16 v[52:55], v[88:91], v[172:175], v[52:55]
    v_mfma_f32_16x16x32_bf16 v[56:59], v[88:91], v[176:179], v[56:59]
    v_mfma_f32_16x16x32_bf16 v[60:63], v[88:91], v[180:183], v[60:63]
    v_mfma_f32_16x16x32_bf16 v[64:67], v[88:91], v[184:187], v[64:67]
    v_mfma_f32_16x16x32_bf16 v[68:71], v[88:91], v[188:191], v[68:71]
    v_mfma_f32_16x16x32_bf16 v[72:75], v[88:91], v[192:195], v[72:75]
    v_mfma_f32_16x16x32_bf16 v[76:79], v[88:91], v[196:199], v[76:79]
    s_waitcnt lgkmcnt(1)
    v_mfma_f32_16x16x32_bf16 v[16:19], v[80:83], v[140:143], v[16:19]
    s_barrier
    v_mfma_f32_16x16x32_bf16 v[20:23], v[80:83], v[144:147], v[20:23]
    ds_read_b64_tr_b16 v[84:85], v228 offset:32768
    v_mfma_f32_16x16x32_bf16 v[24:27], v[80:83], v[148:151], v[24:27]
    ds_read_b64_tr_b16 v[86:87], v228 offset:33280
    v_mfma_f32_16x16x32_bf16 v[28:31], v[80:83], v[152:155], v[28:31]
    ds_read_b128 v[136:139], v222 offset:36352
    v_mfma_f32_16x16x32_bf16 v[32:35], v[80:83], v[156:159], v[32:35]
    v_mfma_f32_16x16x32_bf16 v[36:39], v[80:83], v[160:163], v[36:39]
    v_mfma_f32_16x16x32_bf16 v[40:43], v[80:83], v[164:167], v[40:43]
    v_mfma_f32_16x16x32_bf16 v[44:47], v[80:83], v[168:171], v[44:47]
    v_mfma_f32_16x16x32_bf16 v[48:51], v[80:83], v[172:175], v[48:51]
    v_mfma_f32_16x16x32_bf16 v[52:55], v[80:83], v[176:179], v[52:55]
    v_mfma_f32_16x16x32_bf16 v[56:59], v[80:83], v[180:183], v[56:59]
    v_mfma_f32_16x16x32_bf16 v[60:63], v[80:83], v[184:187], v[60:63]
    v_mfma_f32_16x16x32_bf16 v[64:67], v[80:83], v[188:191], v[64:67]
    v_mfma_f32_16x16x32_bf16 v[68:71], v[80:83], v[192:195], v[68:71]
    v_mfma_f32_16x16x32_bf16 v[72:75], v[80:83], v[196:199], v[72:75]
    v_mfma_f32_16x16x32_bf16 v[76:79], v[80:83], v[200:203], v[76:79]
    s_waitcnt lgkmcnt(1)
    v_mfma_f32_16x16x32_bf16 v[16:19], v[84:87], v[144:147], v[16:19]
    ds_read_b64_tr_b16 v[88:89], v228 offset:36864
    v_mfma_f32_16x16x32_bf16 v[20:23], v[84:87], v[148:151], v[20:23]
    ds_read_b64_tr_b16 v[90:91], v228 offset:37376
    v_mfma_f32_16x16x32_bf16 v[24:27], v[84:87], v[152:155], v[24:27]
    ds_read_b128 v[140:143], v220 offset:36608
    v_mfma_f32_16x16x32_bf16 v[28:31], v[84:87], v[156:159], v[28:31]
    v_mfma_f32_16x16x32_bf16 v[32:35], v[84:87], v[160:163], v[32:35]
    v_mfma_f32_16x16x32_bf16 v[36:39], v[84:87], v[164:167], v[36:39]
    v_mfma_f32_16x16x32_bf16 v[40:43], v[84:87], v[168:171], v[40:43]
L_PAD10:
    s_cbranch_execz L_PAD18
    v_mfma_f32_16x16x32_bf16 v[44:47], v[84:87], v[172:175], v[44:47]
    v_mfma_f32_16x16x32_bf16 v[48:51], v[84:87], v[176:179], v[48:51]
    v_mfma_f32_16x16x32_bf16 v[52:55], v[84:87], v[180:183], v[52:55]
    v_mfma_f32_16x16x32_bf16 v[56:59], v[84:87], v[184:187], v[56:59]
    v_mfma_f32_16x16x32_bf16 v[60:63], v[84:87], v[188:191], v[60:63]
    v_mfma_f32_16x16x32_bf16 v[64:67], v[84:87], v[192:195], v[64:67]
    v_mfma_f32_16x16x32_bf16 v[68:71], v[84:87], v[196:199], v[68:71]
    v_mfma_f32_16x16x32_bf16 v[72:75], v[84:87], v[200:203], v[72:75]
    v_mfma_f32_16x16x32_bf16 v[76:79], v[84:87], v[204:207], v[76:79]
    s_waitcnt lgkmcnt(1)
    v_mfma_f32_16x16x32_bf16 v[16:19], v[88:91], v[148:151], v[16:19]
    s_barrier
    v_mfma_f32_16x16x32_bf16 v[20:23], v[88:91], v[152:155], v[20:23]
    ds_read_b64_tr_b16 v[80:81], v228 offset:40960
    v_mfma_f32_16x16x32_bf16 v[24:27], v[88:91], v[156:159], v[24:27]
    ds_read_b64_tr_b16 v[82:83], v228 offset:41472
    v_mfma_f32_16x16x32_bf16 v[28:31], v[88:91], v[160:163], v[28:31]
    ds_read_b128 v[144:147], v222 offset:36608
    v_mfma_f32_16x16x32_bf16 v[32:35], v[88:91], v[164:167], v[32:35]
    v_mfma_f32_16x16x32_bf16 v[36:39], v[88:91], v[168:171], v[36:39]
    v_mfma_f32_16x16x32_bf16 v[40:43], v[88:91], v[172:175], v[40:43]
    v_mfma_f32_16x16x32_bf16 v[44:47], v[88:91], v[176:179], v[44:47]
    v_mfma_f32_16x16x32_bf16 v[48:51], v[88:91], v[180:183], v[48:51]
    v_mfma_f32_16x16x32_bf16 v[52:55], v[88:91], v[184:187], v[52:55]
    v_mfma_f32_16x16x32_bf16 v[56:59], v[88:91], v[188:191], v[56:59]
    v_mfma_f32_16x16x32_bf16 v[60:63], v[88:91], v[192:195], v[60:63]
    v_mfma_f32_16x16x32_bf16 v[64:67], v[88:91], v[196:199], v[64:67]
    v_mfma_f32_16x16x32_bf16 v[68:71], v[88:91], v[200:203], v[68:71]
    v_mfma_f32_16x16x32_bf16 v[72:75], v[88:91], v[204:207], v[72:75]
    v_mfma_f32_16x16x32_bf16 v[76:79], v[88:91], v[208:211], v[76:79]
    s_waitcnt lgkmcnt(1)
    v_mfma_f32_16x16x32_bf16 v[16:19], v[80:83], v[212:215], v[16:19]
    ds_read_b64_tr_b16 v[84:85], v229 offset:0
    v_mfma_f32_16x16x32_bf16 v[20:23], v[80:83], v[216:219], v[20:23]
    ds_read_b64_tr_b16 v[86:87], v229 offset:512
    v_mfma_f32_16x16x32_bf16 v[24:27], v[80:83], v[92:95], v[24:27]
    ds_read_b128 v[148:151], v224 offset:36864
    v_mfma_f32_16x16x32_bf16 v[28:31], v[80:83], v[96:99], v[28:31]
    ds_read_b128 v[152:155], v226 offset:36864
    v_mfma_f32_16x16x32_bf16 v[32:35], v[80:83], v[100:103], v[32:35]
    ds_read_b128 v[156:159], v224 offset:37120
    v_mfma_f32_16x16x32_bf16 v[36:39], v[80:83], v[104:107], v[36:39]
    ds_read_b128 v[160:163], v226 offset:37120
    v_mfma_f32_16x16x32_bf16 v[40:43], v[80:83], v[108:111], v[40:43]
    v_mfma_f32_16x16x32_bf16 v[44:47], v[80:83], v[112:115], v[44:47]
    s_waitcnt lgkmcnt(6)
    v_mfma_f32_16x16x32_bf16 v[48:51], v[80:83], v[116:119], v[48:51]
    v_mfma_f32_16x16x32_bf16 v[52:55], v[80:83], v[120:123], v[52:55]
    v_mfma_f32_16x16x32_bf16 v[56:59], v[80:83], v[124:127], v[56:59]
    v_mfma_f32_16x16x32_bf16 v[60:63], v[80:83], v[128:131], v[60:63]
    v_mfma_f32_16x16x32_bf16 v[64:67], v[80:83], v[132:135], v[64:67]
    v_mfma_f32_16x16x32_bf16 v[68:71], v[80:83], v[136:139], v[68:71]
    v_mfma_f32_16x16x32_bf16 v[72:75], v[80:83], v[140:143], v[72:75]
    v_mfma_f32_16x16x32_bf16 v[76:79], v[80:83], v[144:147], v[76:79]
    s_waitcnt lgkmcnt(4)
    v_mfma_f32_16x16x32_bf16 v[16:19], v[84:87], v[216:219], v[16:19]
    s_barrier
    v_mfma_f32_16x16x32_bf16 v[20:23], v[84:87], v[92:95], v[20:23]
    ds_read_b64_tr_b16 v[88:89], v229 offset:4096
    v_mfma_f32_16x16x32_bf16 v[24:27], v[84:87], v[96:99], v[24:27]
    ds_read_b64_tr_b16 v[90:91], v229 offset:4608
    v_mfma_f32_16x16x32_bf16 v[28:31], v[84:87], v[100:103], v[28:31]
    ds_read_b128 v[164:167], v224 offset:37376
    v_mfma_f32_16x16x32_bf16 v[32:35], v[84:87], v[104:107], v[32:35]
    ds_read_b128 v[168:171], v226 offset:37376
    v_mfma_f32_16x16x32_bf16 v[36:39], v[84:87], v[108:111], v[36:39]
L_PAD11:
    s_cbranch_execz L_PAD19
    ds_read_b128 v[172:175], v224 offset:37632
    v_mfma_f32_16x16x32_bf16 v[40:43], v[84:87], v[112:115], v[40:43]
    ds_read_b128 v[176:179], v226 offset:37632
    v_mfma_f32_16x16x32_bf16 v[44:47], v[84:87], v[116:119], v[44:47]
    s_waitcnt lgkmcnt(9)
    v_mfma_f32_16x16x32_bf16 v[48:51], v[84:87], v[120:123], v[48:51]
    v_mfma_f32_16x16x32_bf16 v[52:55], v[84:87], v[124:127], v[52:55]
    v_mfma_f32_16x16x32_bf16 v[56:59], v[84:87], v[128:131], v[56:59]
    v_mfma_f32_16x16x32_bf16 v[60:63], v[84:87], v[132:135], v[60:63]
    v_mfma_f32_16x16x32_bf16 v[64:67], v[84:87], v[136:139], v[64:67]
    v_mfma_f32_16x16x32_bf16 v[68:71], v[84:87], v[140:143], v[68:71]
    v_mfma_f32_16x16x32_bf16 v[72:75], v[84:87], v[144:147], v[72:75]
    v_mfma_f32_16x16x32_bf16 v[76:79], v[84:87], v[148:151], v[76:79]
    s_waitcnt lgkmcnt(4)
    v_mfma_f32_16x16x32_bf16 v[16:19], v[88:91], v[92:95], v[16:19]
    ds_read_b64_tr_b16 v[80:81], v229 offset:8192
    v_mfma_f32_16x16x32_bf16 v[20:23], v[88:91], v[96:99], v[20:23]
    ds_read_b64_tr_b16 v[82:83], v229 offset:8704
    v_mfma_f32_16x16x32_bf16 v[24:27], v[88:91], v[100:103], v[24:27]
    ds_read_b128 v[180:183], v224 offset:37888
    v_mfma_f32_16x16x32_bf16 v[28:31], v[88:91], v[104:107], v[28:31]
    ds_read_b128 v[184:187], v226 offset:37888
    v_mfma_f32_16x16x32_bf16 v[32:35], v[88:91], v[108:111], v[32:35]
    ds_read_b128 v[188:191], v224 offset:38144
    v_mfma_f32_16x16x32_bf16 v[36:39], v[88:91], v[112:115], v[36:39]
    ds_read_b128 v[192:195], v226 offset:38144
    v_mfma_f32_16x16x32_bf16 v[40:43], v[88:91], v[116:119], v[40:43]
    v_mfma_f32_16x16x32_bf16 v[44:47], v[88:91], v[120:123], v[44:47]
    v_mfma_f32_16x16x32_bf16 v[48:51], v[88:91], v[124:127], v[48:51]
    v_mfma_f32_16x16x32_bf16 v[52:55], v[88:91], v[128:131], v[52:55]
    v_mfma_f32_16x16x32_bf16 v[56:59], v[88:91], v[132:135], v[56:59]
    v_mfma_f32_16x16x32_bf16 v[60:63], v[88:91], v[136:139], v[60:63]
    v_mfma_f32_16x16x32_bf16 v[64:67], v[88:91], v[140:143], v[64:67]
    v_mfma_f32_16x16x32_bf16 v[68:71], v[88:91], v[144:147], v[68:71]
    v_mfma_f32_16x16x32_bf16 v[72:75], v[88:91], v[148:151], v[72:75]
    v_mfma_f32_16x16x32_bf16 v[76:79], v[88:91], v[152:155], v[76:79]
    s_waitcnt lgkmcnt(4)
    v_mfma_f32_16x16x32_bf16 v[16:19], v[80:83], v[96:99], v[16:19]
    s_barrier
    v_mfma_f32_16x16x32_bf16 v[20:23], v[80:83], v[100:103], v[20:23]
    ds_read_b64_tr_b16 v[84:85], v229 offset:12288
    v_mfma_f32_16x16x32_bf16 v[24:27], v[80:83], v[104:107], v[24:27]
    ds_read_b64_tr_b16 v[86:87], v229 offset:12800
    v_mfma_f32_16x16x32_bf16 v[28:31], v[80:83], v[108:111], v[28:31]
    ds_read_b128 v[196:199], v224 offset:38400
    v_mfma_f32_16x16x32_bf16 v[32:35], v[80:83], v[112:115], v[32:35]
    ds_read_b128 v[200:203], v226 offset:38400
    v_mfma_f32_16x16x32_bf16 v[36:39], v[80:83], v[116:119], v[36:39]
    ds_read_b128 v[204:207], v221 offset:34816
    v_mfma_f32_16x16x32_bf16 v[40:43], v[80:83], v[120:123], v[40:43]
    ds_read_b128 v[208:211], v223 offset:34816
    v_mfma_f32_16x16x32_bf16 v[44:47], v[80:83], v[124:127], v[44:47]
    v_mfma_f32_16x16x32_bf16 v[48:51], v[80:83], v[128:131], v[48:51]
    v_mfma_f32_16x16x32_bf16 v[52:55], v[80:83], v[132:135], v[52:55]
    v_mfma_f32_16x16x32_bf16 v[56:59], v[80:83], v[136:139], v[56:59]
    v_mfma_f32_16x16x32_bf16 v[60:63], v[80:83], v[140:143], v[60:63]
    v_mfma_f32_16x16x32_bf16 v[64:67], v[80:83], v[144:147], v[64:67]
    v_mfma_f32_16x16x32_bf16 v[68:71], v[80:83], v[148:151], v[68:71]
    v_mfma_f32_16x16x32_bf16 v[72:75], v[80:83], v[152:155], v[72:75]
    v_mfma_f32_16x16x32_bf16 v[76:79], v[80:83], v[156:159], v[76:79]
    s_waitcnt lgkmcnt(4)
    v_mfma_f32_16x16x32_bf16 v[16:19], v[84:87], v[100:103], v[16:19]
    ds_read_b64_tr_b16 v[88:89], v229 offset:16384
    v_mfma_f32_16x16x32_bf16 v[20:23], v[84:87], v[104:107], v[20:23]
    ds_read_b64_tr_b16 v[90:91], v229 offset:16896
    v_mfma_f32_16x16x32_bf16 v[24:27], v[84:87], v[108:111], v[24:27]
L_PAD12:
    s_cbranch_execz L_PAD20
    ds_read_b128 v[212:215], v221 offset:35072
    v_mfma_f32_16x16x32_bf16 v[28:31], v[84:87], v[112:115], v[28:31]
    ds_read_b128 v[216:219], v223 offset:35072
    v_mfma_f32_16x16x32_bf16 v[32:35], v[84:87], v[116:119], v[32:35]
    ds_read_b128 v[92:95], v221 offset:35328
    v_mfma_f32_16x16x32_bf16 v[36:39], v[84:87], v[120:123], v[36:39]
    ds_read_b128 v[96:99], v223 offset:35328
    v_mfma_f32_16x16x32_bf16 v[40:43], v[84:87], v[124:127], v[40:43]
    v_mfma_f32_16x16x32_bf16 v[44:47], v[84:87], v[128:131], v[44:47]
    v_mfma_f32_16x16x32_bf16 v[48:51], v[84:87], v[132:135], v[48:51]
    v_mfma_f32_16x16x32_bf16 v[52:55], v[84:87], v[136:139], v[52:55]
    v_mfma_f32_16x16x32_bf16 v[56:59], v[84:87], v[140:143], v[56:59]
    v_mfma_f32_16x16x32_bf16 v[60:63], v[84:87], v[144:147], v[60:63]
    v_mfma_f32_16x16x32_bf16 v[64:67], v[84:87], v[148:151], v[64:67]
    v_mfma_f32_16x16x32_bf16 v[68:71], v[84:87], v[152:155], v[68:71]
    v_mfma_f32_16x16x32_bf16 v[72:75], v[84:87], v[156:159], v[72:75]
    v_mfma_f32_16x16x32_bf16 v[76:79], v[84:87], v[160:163], v[76:79]
    s_waitcnt lgkmcnt(4)
    v_mfma_f32_16x16x32_bf16 v[16:19], v[88:91], v[104:107], v[16:19]
    s_barrier
    v_mfma_f32_16x16x32_bf16 v[20:23], v[88:91], v[108:111], v[20:23]
    ds_read_b64_tr_b16 v[80:81], v229 offset:20480
    v_mfma_f32_16x16x32_bf16 v[24:27], v[88:91], v[112:115], v[24:27]
    ds_read_b64_tr_b16 v[82:83], v229 offset:20992
    v_mfma_f32_16x16x32_bf16 v[28:31], v[88:91], v[116:119], v[28:31]
    ds_read_b128 v[100:103], v221 offset:35584
    v_mfma_f32_16x16x32_bf16 v[32:35], v[88:91], v[120:123], v[32:35]
    v_mfma_f32_16x16x32_bf16 v[36:39], v[88:91], v[124:127], v[36:39]
    v_mfma_f32_16x16x32_bf16 v[40:43], v[88:91], v[128:131], v[40:43]
    v_mfma_f32_16x16x32_bf16 v[44:47], v[88:91], v[132:135], v[44:47]
    v_mfma_f32_16x16x32_bf16 v[48:51], v[88:91], v[136:139], v[48:51]
    v_mfma_f32_16x16x32_bf16 v[52:55], v[88:91], v[140:143], v[52:55]
    v_mfma_f32_16x16x32_bf16 v[56:59], v[88:91], v[144:147], v[56:59]
    v_mfma_f32_16x16x32_bf16 v[60:63], v[88:91], v[148:151], v[60:63]
    v_mfma_f32_16x16x32_bf16 v[64:67], v[88:91], v[152:155], v[64:67]
    v_mfma_f32_16x16x32_bf16 v[68:71], v[88:91], v[156:159], v[68:71]
    v_mfma_f32_16x16x32_bf16 v[72:75], v[88:91], v[160:163], v[72:75]
    v_mfma_f32_16x16x32_bf16 v[76:79], v[88:91], v[164:167], v[76:79]
    s_waitcnt lgkmcnt(1)
    v_mfma_f32_16x16x32_bf16 v[16:19], v[80:83], v[108:111], v[16:19]
    ds_read_b64_tr_b16 v[84:85], v229 offset:24576
    v_mfma_f32_16x16x32_bf16 v[20:23], v[80:83], v[112:115], v[20:23]
    ds_read_b64_tr_b16 v[86:87], v229 offset:25088
    v_mfma_f32_16x16x32_bf16 v[24:27], v[80:83], v[116:119], v[24:27]
    ds_read_b128 v[104:107], v223 offset:35584
    v_mfma_f32_16x16x32_bf16 v[28:31], v[80:83], v[120:123], v[28:31]
    v_mfma_f32_16x16x32_bf16 v[32:35], v[80:83], v[124:127], v[32:35]
    v_mfma_f32_16x16x32_bf16 v[36:39], v[80:83], v[128:131], v[36:39]
    v_mfma_f32_16x16x32_bf16 v[40:43], v[80:83], v[132:135], v[40:43]
    v_mfma_f32_16x16x32_bf16 v[44:47], v[80:83], v[136:139], v[44:47]
    v_mfma_f32_16x16x32_bf16 v[48:51], v[80:83], v[140:143], v[48:51]
    v_mfma_f32_16x16x32_bf16 v[52:55], v[80:83], v[144:147], v[52:55]
    v_mfma_f32_16x16x32_bf16 v[56:59], v[80:83], v[148:151], v[56:59]
    v_mfma_f32_16x16x32_bf16 v[60:63], v[80:83], v[152:155], v[60:63]
    v_mfma_f32_16x16x32_bf16 v[64:67], v[80:83], v[156:159], v[64:67]
    v_mfma_f32_16x16x32_bf16 v[68:71], v[80:83], v[160:163], v[68:71]
    v_mfma_f32_16x16x32_bf16 v[72:75], v[80:83], v[164:167], v[72:75]
    v_mfma_f32_16x16x32_bf16 v[76:79], v[80:83], v[168:171], v[76:79]
    s_waitcnt lgkmcnt(1)
    v_mfma_f32_16x16x32_bf16 v[16:19], v[84:87], v[112:115], v[16:19]
    s_barrier
    v_mfma_f32_16x16x32_bf16 v[20:23], v[84:87], v[116:119], v[20:23]
    ds_read_b64_tr_b16 v[88:89], v229 offset:28672
    v_mfma_f32_16x16x32_bf16 v[24:27], v[84:87], v[120:123], v[24:27]
    ds_read_b64_tr_b16 v[90:91], v229 offset:29184
    v_mfma_f32_16x16x32_bf16 v[28:31], v[84:87], v[124:127], v[28:31]
L_PAD13:
    s_cbranch_execz L_PAD21
    ds_read_b128 v[108:111], v221 offset:35840
    v_mfma_f32_16x16x32_bf16 v[32:35], v[84:87], v[128:131], v[32:35]
    v_mfma_f32_16x16x32_bf16 v[36:39], v[84:87], v[132:135], v[36:39]
    v_mfma_f32_16x16x32_bf16 v[40:43], v[84:87], v[136:139], v[40:43]
    v_mfma_f32_16x16x32_bf16 v[44:47], v[84:87], v[140:143], v[44:47]
    v_mfma_f32_16x16x32_bf16 v[48:51], v[84:87], v[144:147], v[48:51]
    v_mfma_f32_16x16x32_bf16 v[52:55], v[84:87], v[148:151], v[52:55]
    v_mfma_f32_16x16x32_bf16 v[56:59], v[84:87], v[152:155], v[56:59]
    v_mfma_f32_16x16x32_bf16 v[60:63], v[84:87], v[156:159], v[60:63]
    v_mfma_f32_16x16x32_bf16 v[64:67], v[84:87], v[160:163], v[64:67]
    v_mfma_f32_16x16x32_bf16 v[68:71], v[84:87], v[164:167], v[68:71]
    v_mfma_f32_16x16x32_bf16 v[72:75], v[84:87], v[168:171], v[72:75]
    v_mfma_f32_16x16x32_bf16 v[76:79], v[84:87], v[172:175], v[76:79]
    s_waitcnt lgkmcnt(1)
    v_mfma_f32_16x16x32_bf16 v[16:19], v[88:91], v[116:119], v[16:19]
    ds_read_b64_tr_b16 v[80:81], v229 offset:32768
    v_mfma_f32_16x16x32_bf16 v[20:23], v[88:91], v[120:123], v[20:23]
    ds_read_b64_tr_b16 v[82:83], v229 offset:33280
    v_mfma_f32_16x16x32_bf16 v[24:27], v[88:91], v[124:127], v[24:27]
    ds_read_b128 v[112:115], v223 offset:35840
    v_mfma_f32_16x16x32_bf16 v[28:31], v[88:91], v[128:131], v[28:31]
    v_mfma_f32_16x16x32_bf16 v[32:35], v[88:91], v[132:135], v[32:35]
    v_mfma_f32_16x16x32_bf16 v[36:39], v[88:91], v[136:139], v[36:39]
    v_mfma_f32_16x16x32_bf16 v[40:43], v[88:91], v[140:143], v[40:43]
    v_mfma_f32_16x16x32_bf16 v[44:47], v[88:91], v[144:147], v[44:47]
    v_mfma_f32_16x16x32_bf16 v[48:51], v[88:91], v[148:151], v[48:51]
    v_mfma_f32_16x16x32_bf16 v[52:55], v[88:91], v[152:155], v[52:55]
    v_mfma_f32_16x16x32_bf16 v[56:59], v[88:91], v[156:159], v[56:59]
    v_mfma_f32_16x16x32_bf16 v[60:63], v[88:91], v[160:163], v[60:63]
    v_mfma_f32_16x16x32_bf16 v[64:67], v[88:91], v[164:167], v[64:67]
    v_mfma_f32_16x16x32_bf16 v[68:71], v[88:91], v[168:171], v[68:71]
    v_mfma_f32_16x16x32_bf16 v[72:75], v[88:91], v[172:175], v[72:75]
    v_mfma_f32_16x16x32_bf16 v[76:79], v[88:91], v[176:179], v[76:79]
    s_waitcnt lgkmcnt(1)
    v_mfma_f32_16x16x32_bf16 v[16:19], v[80:83], v[120:123], v[16:19]
    s_barrier
    v_mfma_f32_16x16x32_bf16 v[20:23], v[80:83], v[124:127], v[20:23]
    ds_read_b64_tr_b16 v[84:85], v229 offset:36864
    v_mfma_f32_16x16x32_bf16 v[24:27], v[80:83], v[128:131], v[24:27]
    ds_read_b64_tr_b16 v[86:87], v229 offset:37376
    v_mfma_f32_16x16x32_bf16 v[28:31], v[80:83], v[132:135], v[28:31]
    ds_read_b128 v[116:119], v221 offset:36096
    v_mfma_f32_16x16x32_bf16 v[32:35], v[80:83], v[136:139], v[32:35]
    ds_read_b32 v10, v7
    v_mfma_f32_16x16x32_bf16 v[36:39], v[80:83], v[140:143], v[36:39]
    v_mfma_f32_16x16x32_bf16 v[40:43], v[80:83], v[144:147], v[40:43]
    v_mfma_f32_16x16x32_bf16 v[44:47], v[80:83], v[148:151], v[44:47]
    v_mfma_f32_16x16x32_bf16 v[48:51], v[80:83], v[152:155], v[48:51]
    v_mfma_f32_16x16x32_bf16 v[52:55], v[80:83], v[156:159], v[52:55]
    v_mfma_f32_16x16x32_bf16 v[56:59], v[80:83], v[160:163], v[56:59]
    v_mfma_f32_16x16x32_bf16 v[60:63], v[80:83], v[164:167], v[60:63]
    v_mfma_f32_16x16x32_bf16 v[64:67], v[80:83], v[168:171], v[64:67]
    v_mfma_f32_16x16x32_bf16 v[68:71], v[80:83], v[172:175], v[68:71]
    v_mfma_f32_16x16x32_bf16 v[72:75], v[80:83], v[176:179], v[72:75]
    v_mfma_f32_16x16x32_bf16 v[76:79], v[80:83], v[180:183], v[76:79]
    s_waitcnt lgkmcnt(2)
    v_mfma_f32_16x16x32_bf16 v[16:19], v[84:87], v[124:127], v[16:19]
    ds_read_b64_tr_b16 v[88:89], v229 offset:40960
    v_mfma_f32_16x16x32_bf16 v[20:23], v[84:87], v[128:131], v[20:23]
    ds_read_b64_tr_b16 v[90:91], v229 offset:41472
    v_mfma_f32_16x16x32_bf16 v[24:27], v[84:87], v[132:135], v[24:27]
    ds_read_b128 v[120:123], v223 offset:36096
    v_mfma_f32_16x16x32_bf16 v[28:31], v[84:87], v[136:139], v[28:31]
    v_mfma_f32_16x16x32_bf16 v[32:35], v[84:87], v[140:143], v[32:35]
    v_mfma_f32_16x16x32_bf16 v[36:39], v[84:87], v[144:147], v[36:39]
    v_mfma_f32_16x16x32_bf16 v[40:43], v[84:87], v[148:151], v[40:43]
L_PAD14:
    s_cbranch_execz L_PAD22
    v_mfma_f32_16x16x32_bf16 v[44:47], v[84:87], v[152:155], v[44:47]
    v_mfma_f32_16x16x32_bf16 v[48:51], v[84:87], v[156:159], v[48:51]
    v_mfma_f32_16x16x32_bf16 v[52:55], v[84:87], v[160:163], v[52:55]
    v_mfma_f32_16x16x32_bf16 v[56:59], v[84:87], v[164:167], v[56:59]
    v_mfma_f32_16x16x32_bf16 v[60:63], v[84:87], v[168:171], v[60:63]
    v_mfma_f32_16x16x32_bf16 v[64:67], v[84:87], v[172:175], v[64:67]
    v_mfma_f32_16x16x32_bf16 v[68:71], v[84:87], v[176:179], v[68:71]
    v_mfma_f32_16x16x32_bf16 v[72:75], v[84:87], v[180:183], v[72:75]
    v_mfma_f32_16x16x32_bf16 v[76:79], v[84:87], v[184:187], v[76:79]
    s_waitcnt lgkmcnt(3)
    s_waitcnt lgkmcnt(1)
    v_mfma_f32_16x16x32_bf16 v[16:19], v[88:91], v[128:131], v[16:19]
    s_barrier
    v_readfirstlane_b32 s61, v10
    v_mfma_f32_16x16x32_bf16 v[20:23], v[88:91], v[132:135], v[20:23]
    ds_read_b64_tr_b16 v[80:81], v228 offset:0
    s_nop 0
    v_mfma_f32_16x16x32_bf16 v[24:27], v[88:91], v[136:139], v[24:27]
    ds_read_b64_tr_b16 v[82:83], v228 offset:512
    s_cmp_eq_u32 s61, 1
    v_mfma_f32_16x16x32_bf16 v[28:31], v[88:91], v[140:143], v[28:31]
    ds_read_b128 v[124:127], v221 offset:36352
    s_cselect_b32 s48, 0, 4194304
    v_mfma_f32_16x16x32_bf16 v[32:35], v[88:91], v[144:147], v[32:35]
    s_add_u32 s58, s58, s48
    s_lshl_b32 s48, s48, 1
    v_mfma_f32_16x16x32_bf16 v[36:39], v[88:91], v[148:151], v[36:39]
    s_add_u32 s55, s55, s48
    s_add_u32 s56, s56, s48
    v_mfma_f32_16x16x32_bf16 v[40:43], v[88:91], v[152:155], v[40:43]
    s_add_u32 s57, s56, 32768
    s_cmp_eq_u32 s61, 1
    v_mfma_f32_16x16x32_bf16 v[44:47], v[88:91], v[156:159], v[44:47]
    v_mfma_f32_16x16x32_bf16 v[48:51], v[88:91], v[160:163], v[48:51]
    v_mfma_f32_16x16x32_bf16 v[52:55], v[88:91], v[164:167], v[52:55]
    v_mfma_f32_16x16x32_bf16 v[56:59], v[88:91], v[168:171], v[56:59]
    v_mfma_f32_16x16x32_bf16 v[60:63], v[88:91], v[172:175], v[60:63]
    v_mfma_f32_16x16x32_bf16 v[64:67], v[88:91], v[176:179], v[64:67]
    v_mfma_f32_16x16x32_bf16 v[68:71], v[88:91], v[180:183], v[68:71]
    v_mfma_f32_16x16x32_bf16 v[72:75], v[88:91], v[184:187], v[72:75]
    v_mfma_f32_16x16x32_bf16 v[76:79], v[88:91], v[188:191], v[76:79]
    s_waitcnt lgkmcnt(1)
    v_mfma_f32_16x16x32_bf16 v[16:19], v[80:83], v[132:135], v[16:19]
    ds_read_b64_tr_b16 v[84:85], v228 offset:4096
    v_mfma_f32_16x16x32_bf16 v[20:23], v[80:83], v[136:139], v[20:23]
    ds_read_b64_tr_b16 v[86:87], v228 offset:4608
    v_mfma_f32_16x16x32_bf16 v[24:27], v[80:83], v[140:143], v[24:27]
    ds_read_b128 v[128:131], v223 offset:36352
    v_mfma_f32_16x16x32_bf16 v[28:31], v[80:83], v[144:147], v[28:31]
    v_mfma_f32_16x16x32_bf16 v[32:35], v[80:83], v[148:151], v[32:35]
    v_mfma_f32_16x16x32_bf16 v[36:39], v[80:83], v[152:155], v[36:39]
    v_mfma_f32_16x16x32_bf16 v[40:43], v[80:83], v[156:159], v[40:43]
    v_mfma_f32_16x16x32_bf16 v[44:47], v[80:83], v[160:163], v[44:47]
    v_mfma_f32_16x16x32_bf16 v[48:51], v[80:83], v[164:167], v[48:51]
    v_mfma_f32_16x16x32_bf16 v[52:55], v[80:83], v[168:171], v[52:55]
    v_mfma_f32_16x16x32_bf16 v[56:59], v[80:83], v[172:175], v[56:59]
    v_mfma_f32_16x16x32_bf16 v[60:63], v[80:83], v[176:179], v[60:63]
    v_mfma_f32_16x16x32_bf16 v[64:67], v[80:83], v[180:183], v[64:67]
    v_mfma_f32_16x16x32_bf16 v[68:71], v[80:83], v[184:187], v[68:71]
    v_mfma_f32_16x16x32_bf16 v[72:75], v[80:83], v[188:191], v[72:75]
    v_mfma_f32_16x16x32_bf16 v[76:79], v[80:83], v[192:195], v[76:79]
    s_waitcnt lgkmcnt(1)
    v_mfma_f32_16x16x32_bf16 v[16:19], v[84:87], v[136:139], v[16:19]
    s_barrier
    v_mfma_f32_16x16x32_bf16 v[20:23], v[84:87], v[140:143], v[20:23]
    ds_read_b64_tr_b16 v[88:89], v228 offset:8192
    v_mfma_f32_16x16x32_bf16 v[24:27], v[84:87], v[144:147], v[24:27]
    ds_read_b64_tr_b16 v[90:91], v228 offset:8704
    v_mfma_f32_16x16x32_bf16 v[28:31], v[84:87], v[148:151], v[28:31]
    ds_read_b128 v[132:135], v221 offset:36608
L_PAD15:
    s_cbranch_execz L_PAD23
    v_mfma_f32_16x16x32_bf16 v[32:35], v[84:87], v[152:155], v[32:35]
    v_mfma_f32_16x16x32_bf16 v[36:39], v[84:87], v[156:159], v[36:39]
    v_mfma_f32_16x16x32_bf16 v[40:43], v[84:87], v[160:163], v[40:43]
    v_mfma_f32_16x16x32_bf16 v[44:47], v[84:87], v[164:167], v[44:47]
    v_mfma_f32_16x16x32_bf16 v[48:51], v[84:87], v[168:171], v[48:51]
    v_mfma_f32_16x16x32_bf16 v[52:55], v[84:87], v[172:175], v[52:55]
    v_mfma_f32_16x16x32_bf16 v[56:59], v[84:87], v[176:179], v[56:59]
    v_mfma_f32_16x16x32_bf16 v[60:63], v[84:87], v[180:183], v[60:63]
    v_mfma_f32_16x16x32_bf16 v[64:67], v[84:87], v[184:187], v[64:67]
    v_mfma_f32_16x16x32_bf16 v[68:71], v[84:87], v[188:191], v[68:71]
    v_mfma_f32_16x16x32_bf16 v[72:75], v[84:87], v[192:195], v[72:75]
    v_mfma_f32_16x16x32_bf16 v[76:79], v[84:87], v[196:199], v[76:79]
    s_waitcnt lgkmcnt(1)
    v_mfma_f32_16x16x32_bf16 v[16:19], v[88:91], v[140:143], v[16:19]
    ds_read_b64_tr_b16 v[80:81], v228 offset:12288
    v_mfma_f32_16x16x32_bf16 v[20:23], v[88:91], v[144:147], v[20:23]
    ds_read_b64_tr_b16 v[82:83], v228 offset:12800
    v_mfma_f32_16x16x32_bf16 v[24:27], v[88:91], v[148:151], v[24:27]
    ds_read_b64_tr_b16 v[84:85], v228 offset:16384
    v_mfma_f32_16x16x32_bf16 v[28:31], v[88:91], v[152:155], v[28:31]
    ds_read_b64_tr_b16 v[86:87], v228 offset:16896
    v_mfma_f32_16x16x32_bf16 v[32:35], v[88:91], v[156:159], v[32:35]
    ds_read_b128 v[136:139], v223 offset:36608
    v_mfma_f32_16x16x32_bf16 v[36:39], v[88:91], v[160:163], v[36:39]
    v_mfma_f32_16x16x32_bf16 v[40:43], v[88:91], v[164:167], v[40:43]
    v_mfma_f32_16x16x32_bf16 v[44:47], v[88:91], v[168:171], v[44:47]
    v_mfma_f32_16x16x32_bf16 v[48:51], v[88:91], v[172:175], v[48:51]
    v_mfma_f32_16x16x32_bf16 v[52:55], v[88:91], v[176:179], v[52:55]
    v_mfma_f32_16x16x32_bf16 v[56:59], v[88:91], v[180:183], v[56:59]
    v_mfma_f32_16x16x32_bf16 v[60:63], v[88:91], v[184:187], v[60:63]
    v_mfma_f32_16x16x32_bf16 v[64:67], v[88:91], v[188:191], v[64:67]
    v_mfma_f32_16x16x32_bf16 v[68:71], v[88:91], v[192:195], v[68:71]
    v_mfma_f32_16x16x32_bf16 v[72:75], v[88:91], v[196:199], v[72:75]
    v_mfma_f32_16x16x32_bf16 v[76:79], v[88:91], v[200:203], v[76:79]
    s_waitcnt lgkmcnt(3)
    v_mfma_f32_16x16x32_bf16 v[16:19], v[80:83], v[204:207], v[16:19]
    ds_read_b64_tr_b16 v[88:89], v228 offset:20480
    v_mfma_f32_16x16x32_bf16 v[20:23], v[80:83], v[208:211], v[20:23]
    ds_read_b64_tr_b16 v[90:91], v228 offset:20992
    v_mfma_f32_16x16x32_bf16 v[24:27], v[80:83], v[212:215], v[24:27]
    ds_read_b128 v[140:143], v225 offset:36864
    v_mfma_f32_16x16x32_bf16 v[28:31], v[80:83], v[216:219], v[28:31]
    ds_read_b128 v[144:147], v227 offset:36864
    v_mfma_f32_16x16x32_bf16 v[32:35], v[80:83], v[92:95], v[32:35]
    ds_read_b128 v[148:151], v225 offset:37120
    v_mfma_f32_16x16x32_bf16 v[36:39], v[80:83], v[96:99], v[36:39]
    ds_read_b128 v[152:155], v227 offset:37120
    v_mfma_f32_16x16x32_bf16 v[40:43], v[80:83], v[100:103], v[40:43]
    ds_read_b128 v[156:159], v225 offset:37376
    v_mfma_f32_16x16x32_bf16 v[44:47], v[80:83], v[104:107], v[44:47]
    s_waitcnt lgkmcnt(8)
    v_mfma_f32_16x16x32_bf16 v[16:19], v[84:87], v[208:211], v[16:19]
    ds_read_b64_tr_b16 v[80:81], v228 offset:24576
    v_mfma_f32_16x16x32_bf16 v[20:23], v[84:87], v[212:215], v[20:23]
    ds_read_b64_tr_b16 v[82:83], v228 offset:25088
    v_mfma_f32_16x16x32_bf16 v[24:27], v[84:87], v[216:219], v[24:27]
    ds_read_b128 v[160:163], v227 offset:37376
    v_mfma_f32_16x16x32_bf16 v[28:31], v[84:87], v[92:95], v[28:31]
    ds_read_b128 v[164:167], v225 offset:37632
    v_mfma_f32_16x16x32_bf16 v[32:35], v[84:87], v[96:99], v[32:35]
    ds_read_b128 v[168:171], v227 offset:37632
    v_mfma_f32_16x16x32_bf16 v[36:39], v[84:87], v[100:103], v[36:39]
    ds_read_b128 v[172:175], v225 offset:37888
    v_mfma_f32_16x16x32_bf16 v[40:43], v[84:87], v[104:107], v[40:43]
    ds_read_b128 v[176:179], v227 offset:37888
L_PAD16:
    s_cbranch_execz L_PAD24
    v_mfma_f32_16x16x32_bf16 v[44:47], v[84:87], v[108:111], v[44:47]
    s_waitcnt lgkmcnt(12)
    v_mfma_f32_16x16x32_bf16 v[16:19], v[88:91], v[212:215], v[16:19]
    s_barrier
    v_mfma_f32_16x16x32_bf16 v[20:23], v[88:91], v[216:219], v[20:23]
    ds_read_b64_tr_b16 v[84:85], v228 offset:28672
    v_mfma_f32_16x16x32_bf16 v[24:27], v[88:91], v[92:95], v[24:27]
    ds_read_b64_tr_b16 v[86:87], v228 offset:29184
    v_mfma_f32_16x16x32_bf16 v[28:31], v[88:91], v[96:99], v[28:31]
    ds_read_b128 v[180:183], v225 offset:38144
    v_mfma_f32_16x16x32_bf16 v[32:35], v[88:91], v[100:103], v[32:35]
    ds_read_b128 v[184:187], v227 offset:38144
    v_mfma_f32_16x16x32_bf16 v[36:39], v[88:91], v[104:107], v[36:39]
    ds_read_b128 v[188:191], v225 offset:38400
    v_mfma_f32_16x16x32_bf16 v[40:43], v[88:91], v[108:111], v[40:43]
    ds_read_b128 v[192:195], v227 offset:38400
    v_mfma_f32_16x16x32_bf16 v[44:47], v[88:91], v[112:115], v[44:47]
    s_waitcnt lgkmcnt(11)
    v_mfma_f32_16x16x32_bf16 v[16:19], v[80:83], v[216:219], v[16:19]
    ds_read_b64_tr_b16 v[88:89], v228 offset:32768
    v_mfma_f32_16x16x32_bf16 v[20:23], v[80:83], v[92:95], v[20:23]
    ds_read_b64_tr_b16 v[90:91], v228 offset:33280
    v_mfma_f32_16x16x32_bf16 v[24:27], v[80:83], v[96:99], v[24:27]
    v_mfma_f32_16x16x32_bf16 v[28:31], v[80:83], v[100:103], v[28:31]
    v_mfma_f32_16x16x32_bf16 v[32:35], v[80:83], v[104:107], v[32:35]
    v_mfma_f32_16x16x32_bf16 v[36:39], v[80:83], v[108:111], v[36:39]
    v_mfma_f32_16x16x32_bf16 v[40:43], v[80:83], v[112:115], v[40:43]
    v_mfma_f32_16x16x32_bf16 v[44:47], v[80:83], v[116:119], v[44:47]
    s_waitcnt lgkmcnt(6)
    v_mfma_f32_16x16x32_bf16 v[16:19], v[84:87], v[92:95], v[16:19]
    ds_read_b64_tr_b16 v[80:81], v228 offset:36864
    v_mfma_f32_16x16x32_bf16 v[20:23], v[84:87], v[96:99], v[20:23]
    ds_read_b64_tr_b16 v[82:83], v228 offset:37376
    v_mfma_f32_16x16x32_bf16 v[24:27], v[84:87], v[100:103], v[24:27]
    v_mfma_f32_16x16x32_bf16 v[28:31], v[84:87], v[104:107], v[28:31]
    v_mfma_f32_16x16x32_bf16 v[32:35], v[84:87], v[108:111], v[32:35]
    v_mfma_f32_16x16x32_bf16 v[36:39], v[84:87], v[112:115], v[36:39]
    v_mfma_f32_16x16x32_bf16 v[40:43], v[84:87], v[116:119], v[40:43]
    v_mfma_f32_16x16x32_bf16 v[44:47], v[84:87], v[120:123], v[44:47]
    s_waitcnt lgkmcnt(2)
    v_mfma_f32_16x16x32_bf16 v[16:19], v[88:91], v[96:99], v[16:19]
    ds_read_b64_tr_b16 v[84:85], v228 offset:40960
    v_mfma_f32_16x16x32_bf16 v[20:23], v[88:91], v[100:103], v[20:23]
    ds_read_b64_tr_b16 v[86:87], v228 offset:41472
    v_mfma_f32_16x16x32_bf16 v[24:27], v[88:91], v[104:107], v[24:27]
    v_mfma_f32_16x16x32_bf16 v[28:31], v[88:91], v[108:111], v[28:31]
    v_mfma_f32_16x16x32_bf16 v[32:35], v[88:91], v[112:115], v[32:35]
    v_mfma_f32_16x16x32_bf16 v[36:39], v[88:91], v[116:119], v[36:39]
    v_mfma_f32_16x16x32_bf16 v[40:43], v[88:91], v[120:123], v[40:43]
    v_mfma_f32_16x16x32_bf16 v[44:47], v[88:91], v[124:127], v[44:47]
    s_waitcnt lgkmcnt(2)
    v_mfma_f32_16x16x32_bf16 v[16:19], v[80:83], v[100:103], v[16:19]
    ds_read_b64_tr_b16 v[88:89], v229 offset:0
    v_mfma_f32_16x16x32_bf16 v[20:23], v[80:83], v[104:107], v[20:23]
    ds_read_b64_tr_b16 v[90:91], v229 offset:512
    v_mfma_f32_16x16x32_bf16 v[24:27], v[80:83], v[108:111], v[24:27]
    v_mfma_f32_16x16x32_bf16 v[28:31], v[80:83], v[112:115], v[28:31]
    v_mfma_f32_16x16x32_bf16 v[32:35], v[80:83], v[116:119], v[32:35]
    v_mfma_f32_16x16x32_bf16 v[36:39], v[80:83], v[120:123], v[36:39]
    v_mfma_f32_16x16x32_bf16 v[40:43], v[80:83], v[124:127], v[40:43]
    v_mfma_f32_16x16x32_bf16 v[44:47], v[80:83], v[128:131], v[44:47]
    s_waitcnt lgkmcnt(2)
    v_mfma_f32_16x16x32_bf16 v[16:19], v[84:87], v[104:107], v[16:19]
    s_barrier
    v_mfma_f32_16x16x32_bf16 v[20:23], v[84:87], v[108:111], v[20:23]
    ds_read_b64_tr_b16 v[80:81], v229 offset:4096
    v_mfma_f32_16x16x32_bf16 v[24:27], v[84:87], v[112:115], v[24:27]
    ds_read_b64_tr_b16 v[82:83], v229 offset:4608
L_PAD17:
    s_cbranch_execz L_PADRETC
    v_mfma_f32_16x16x32_bf16 v[28:31], v[84:87], v[116:119], v[28:31]
    v_mfma_f32_16x16x32_bf16 v[32:35], v[84:87], v[120:123], v[32:35]
    v_mfma_f32_16x16x32_bf16 v[36:39], v[84:87], v[124:127], v[36:39]
    v_mfma_f32_16x16x32_bf16 v[40:43], v[84:87], v[128:131], v[40:43]
    v_mfma_f32_16x16x32_bf16 v[44:47], v[84:87], v[132:135], v[44:47]
    s_waitcnt lgkmcnt(2)
    v_mfma_f32_16x16x32_bf16 v[16:19], v[88:91], v[108:111], v[16:19]
    ds_read_b64_tr_b16 v[84:85], v229 offset:8192
    v_mfma_f32_16x16x32_bf16 v[20:23], v[88:91], v[112:115], v[20:23]
    ds_read_b64_tr_b16 v[86:87], v229 offset:8704
    v_mfma_f32_16x16x32_bf16 v[24:27], v[88:91], v[116:119], v[24:27]
    v_mfma_f32_16x16x32_bf16 v[28:31], v[88:91], v[120:123], v[28:31]
    v_mfma_f32_16x16x32_bf16 v[32:35], v[88:91], v[124:127], v[32:35]
    v_mfma_f32_16x16x32_bf16 v[36:39], v[88:91], v[128:131], v[36:39]
    v_mfma_f32_16x16x32_bf16 v[40:43], v[88:91], v[132:135], v[40:43]
    v_mfma_f32_16x16x32_bf16 v[44:47], v[88:91], v[136:139], v[44:47]
    s_waitcnt lgkmcnt(2)
    v_mfma_f32_16x16x32_bf16 v[16:19], v[80:83], v[112:115], v[16:19]
    ds_read_b64_tr_b16 v[88:89], v229 offset:12288
    v_mfma_f32_16x16x32_bf16 v[20:23], v[80:83], v[116:119], v[20:23]
    ds_read_b64_tr_b16 v[90:91], v229 offset:12800
    v_mfma_f32_16x16x32_bf16 v[24:27], v[80:83], v[120:123], v[24:27]
    v_mfma_f32_16x16x32_bf16 v[28:31], v[80:83], v[124:127], v[28:31]
    v_mfma_f32_16x16x32_bf16 v[32:35], v[80:83], v[128:131], v[32:35]
    v_mfma_f32_16x16x32_bf16 v[36:39], v[80:83], v[132:135], v[36:39]
    v_mfma_f32_16x16x32_bf16 v[40:43], v[80:83], v[136:139], v[40:43]
    v_mfma_f32_16x16x32_bf16 v[44:47], v[80:83], v[140:143], v[44:47]
    s_waitcnt lgkmcnt(2)
    v_mfma_f32_16x16x32_bf16 v[16:19], v[84:87], v[116:119], v[16:19]
    ds_read_b64_tr_b16 v[80:81], v229 offset:16384
    v_mfma_f32_16x16x32_bf16 v[20:23], v[84:87], v[120:123], v[20:23]
    ds_read_b64_tr_b16 v[82:83], v229 offset:16896
    v_mfma_f32_16x16x32_bf16 v[24:27], v[84:87], v[124:127], v[24:27]
    v_mfma_f32_16x16x32_bf16 v[28:31], v[84:87], v[128:131], v[28:31]
    v_mfma_f32_16x16x32_bf16 v[32:35], v[84:87], v[132:135], v[32:35]
    v_mfma_f32_16x16x32_bf16 v[36:39], v[84:87], v[136:139], v[36:39]
    v_mfma_f32_16x16x32_bf16 v[40:43], v[84:87], v[140:143], v[40:43]
    v_mfma_f32_16x16x32_bf16 v[44:47], v[84:87], v[144:147], v[44:47]
    s_waitcnt lgkmcnt(2)
    v_mfma_f32_16x16x32_bf16 v[16:19], v[88:91], v[120:123], v[16:19]
    ds_read_b64_tr_b16 v[84:85], v229 offset:20480
    v_mfma_f32_16x16x32_bf16 v[20:23], v[88:91], v[124:127], v[20:23]
    ds_read_b64_tr_b16 v[86:87], v229 offset:20992
    v_mfma_f32_16x16x32_bf16 v[24:27], v[88:91], v[128:131], v[24:27]
    v_mfma_f32_16x16x32_bf16 v[28:31], v[88:91], v[132:135], v[28:31]
    v_mfma_f32_16x16x32_bf16 v[32:35], v[88:91], v[136:139], v[32:35]
    v_mfma_f32_16x16x32_bf16 v[36:39], v[88:91], v[140:143], v[36:39]
    v_mfma_f32_16x16x32_bf16 v[40:43], v[88:91], v[144:147], v[40:43]
    v_mfma_f32_16x16x32_bf16 v[44:47], v[88:91], v[148:151], v[44:47]
    s_waitcnt lgkmcnt(2)
    v_mfma_f32_16x16x32_bf16 v[16:19], v[80:83], v[124:127], v[16:19]
    ds_read_b64_tr_b16 v[88:89], v229 offset:24576
    v_mfma_f32_16x16x32_bf16 v[20:23], v[80:83], v[128:131], v[20:23]
    ds_read_b64_tr_b16 v[90:91], v229 offset:25088
    v_mfma_f32_16x16x32_bf16 v[24:27], v[80:83], v[132:135], v[24:27]
    v_mfma_f32_16x16x32_bf16 v[28:31], v[80:83], v[136:139], v[28:31]
    v_mfma_f32_16x16x32_bf16 v[32:35], v[80:83], v[140:143], v[32:35]
    v_mfma_f32_16x16x32_bf16 v[36:39], v[80:83], v[144:147], v[36:39]
    v_mfma_f32_16x16x32_bf16 v[40:43], v[80:83], v[148:151], v[40:43]
    v_mfma_f32_16x16x32_bf16 v[44:47], v[80:83], v[152:155], v[44:47]
    s_waitcnt lgkmcnt(2)
    v_mfma_f32_16x16x32_bf16 v[16:19], v[84:87], v[128:131], v[16:19]
    ds_read_b64_tr_b16 v[80:81], v228 offset:12288
    v_mfma_f32_16x16x32_bf16 v[20:23], v[84:87], v[132:135], v[20:23]
    ds_read_b64_tr_b16 v[82:83], v228 offset:12800
    v_mfma_f32_16x16x32_bf16 v[24:27], v[84:87], v[136:139], v[24:27]
L_PAD18:
    s_cbranch_execz L_PADRETL
    v_mfma_f32_16x16x32_bf16 v[28:31], v[84:87], v[140:143], v[28:31]
    v_mfma_f32_16x16x32_bf16 v[32:35], v[84:87], v[144:147], v[32:35]
    v_mfma_f32_16x16x32_bf16 v[36:39], v[84:87], v[148:151], v[36:39]
    v_mfma_f32_16x16x32_bf16 v[40:43], v[84:87], v[152:155], v[40:43]
    v_mfma_f32_16x16x32_bf16 v[44:47], v[84:87], v[156:159], v[44:47]
    s_waitcnt lgkmcnt(2)
    v_mfma_f32_16x16x32_bf16 v[16:19], v[88:91], v[132:135], v[16:19]
    ds_read_b64_tr_b16 v[84:85], v228 offset:16384
    v_mfma_f32_16x16x32_bf16 v[20:23], v[88:91], v[136:139], v[20:23]
    ds_read_b64_tr_b16 v[86:87], v228 offset:16896
    v_mfma_f32_16x16x32_bf16 v[24:27], v[88:91], v[140:143], v[24:27]
    v_mfma_f32_16x16x32_bf16 v[28:31], v[88:91], v[144:147], v[28:31]
    v_mfma_f32_16x16x32_bf16 v[32:35], v[88:91], v[148:151], v[32:35]
    v_mfma_f32_16x16x32_bf16 v[36:39], v[88:91], v[152:155], v[36:39]
    v_mfma_f32_16x16x32_bf16 v[40:43], v[88:91], v[156:159], v[40:43]
    v_mfma_f32_16x16x32_bf16 v[44:47], v[88:91], v[160:163], v[44:47]
    s_waitcnt lgkmcnt(2)
    v_mfma_f32_16x16x32_bf16 v[48:51], v[80:83], v[108:111], v[48:51]
    ds_read_b64_tr_b16 v[88:89], v228 offset:20480
    v_mfma_f32_16x16x32_bf16 v[52:55], v[80:83], v[112:115], v[52:55]
    ds_read_b64_tr_b16 v[90:91], v228 offset:20992
    v_mfma_f32_16x16x32_bf16 v[56:59], v[80:83], v[116:119], v[56:59]
    v_mfma_f32_16x16x32_bf16 v[60:63], v[80:83], v[120:123], v[60:63]
    v_cvt_pk_bf16_f32 v204, v16, v17
    v_cvt_pk_bf16_f32 v205, v18, v19
    v_mfma_f32_16x16x32_bf16 v[64:67], v[80:83], v[124:127], v[64:67]
    v_cvt_pk_bf16_f32 v206, v20, v21
    v_cvt_pk_bf16_f32 v207, v22, v23
    v_mfma_f32_16x16x32_bf16 v[68:71], v[80:83], v[128:131], v[68:71]
    s_cbranch_scc0 L_SL0
    buffer_store_dwordx4 v[204:207], v230, s[28:31], s58 offen offset:0
L_SB0:
    v_cvt_pk_bf16_f32 v208, v24, v25
    v_mfma_f32_16x16x32_bf16 v[72:75], v[80:83], v[132:135], v[72:75]
    v_cvt_pk_bf16_f32 v209, v26, v27
    v_cvt_pk_bf16_f32 v210, v28, v29
    v_mfma_f32_16x16x32_bf16 v[76:79], v[80:83], v[136:139], v[76:79]
    v_cvt_pk_bf16_f32 v211, v30, v31
    s_cbranch_scc0 L_SL1
    buffer_store_dwordx4 v[208:211], v230, s[28:31], s58 offen offset:1024
L_SB1:
    s_waitcnt lgkmcnt(2)
    v_mfma_f32_16x16x32_bf16 v[48:51], v[84:87], v[112:115], v[48:51]
    ds_read_b64_tr_b16 v[80:81], v228 offset:24576
    v_cvt_pk_bf16_f32 v212, v32, v33
    v_mfma_f32_16x16x32_bf16 v[52:55], v[84:87], v[116:119], v[52:55]
    ds_read_b64_tr_b16 v[82:83], v228 offset:25088
    v_cvt_pk_bf16_f32 v213, v34, v35
    v_mfma_f32_16x16x32_bf16 v[56:59], v[84:87], v[120:123], v[56:59]
    v_cvt_pk_bf16_f32 v214, v36, v37
    v_cvt_pk_bf16_f32 v215, v38, v39
    v_mfma_f32_16x16x32_bf16 v[60:63], v[84:87], v[124:127], v[60:63]
    s_cbranch_scc0 L_SL2
    buffer_store_dwordx4 v[212:215], v230, s[28:31], s58 offen offset:2048
L_SB2:
    v_cvt_pk_bf16_f32 v216, v40, v41
    v_mfma_f32_16x16x32_bf16 v[64:67], v[84:87], v[128:131], v[64:67]
    v_cvt_pk_bf16_f32 v217, v42, v43
    v_cvt_pk_bf16_f32 v218, v44, v45
    v_mfma_f32_16x16x32_bf16 v[68:71], v[84:87], v[132:135], v[68:71]
    v_cvt_pk_bf16_f32 v219, v46, v47
    s_cbranch_scc0 L_SL3
    buffer_store_dwordx4 v[216:219], v230, s[28:31], s58 offen offset:3072
L_SB3:
    v_mfma_f32_16x16x32_bf16 v[72:75], v[84:87], v[136:139], v[72:75]
    v_mfma_f32_16x16x32_bf16 v[76:79], v[84:87], v[140:143], v[76:79]
    s_waitcnt lgkmcnt(2)
    v_mfma_f32_16x16x32_bf16 v[48:51], v[88:91], v[116:119], v[48:51]
    ds_read_b64_tr_b16 v[84:85], v228 offset:28672
    v_mfma_f32_16x16x32_bf16 v[52:55], v[88:91], v[120:123], v[52:55]
    ds_read_b64_tr_b16 v[86:87], v228 offset:29184
    v_mfma_f32_16x16x32_bf16 v[56:59], v[88:91], v[124:127], v[56:59]
L_LATE0:
    s_cbranch_execz L_LATE4
    v_mfma_f32_16x16x32_bf16 v[60:63], v[88:91], v[128:131], v[60:63]
    v_mfma_f32_16x16x32_bf16 v[64:67], v[88:91], v[132:135], v[64:67]
    v_mfma_f32_16x16x32_bf16 v[68:71], v[88:91], v[136:139], v[68:71]
    v_mfma_f32_16x16x32_bf16 v[72:75], v[88:91], v[140:143], v[72:75]
    v_mfma_f32_16x16x32_bf16 v[76:79], v[88:91], v[144:147], v[76:79]
    s_waitcnt lgkmcnt(2)
    v_mfma_f32_16x16x32_bf16 v[48:51], v[80:83], v[120:123], v[48:51]
    ds_read_b64_tr_b16 v[88:89], v228 offset:32768
    v_mfma_f32_16x16x32_bf16 v[52:55], v[80:83], v[124:127], v[52:55]
    ds_read_b64_tr_b16 v[90:91], v228 offset:33280
    v_mfma_f32_16x16x32_bf16 v[56:59], v[80:83], v[128:131], v[56:59]
    v_mfma_f32_16x16x32_bf16 v[60:63], v[80:83], v[132:135], v[60:63]
    v_mfma_f32_16x16x32_bf16 v[64:67], v[80:83], v[136:139], v[64:67]
    v_mfma_f32_16x16x32_bf16 v[68:71], v[80:83], v[140:143], v[68:71]
    v_mfma_f32_16x16x32_bf16 v[72:75], v[80:83], v[144:147], v[72:75]
    v_mfma_f32_16x16x32_bf16 v[76:79], v[80:83], v[148:151], v[76:79]
    s_waitcnt lgkmcnt(2)
    v_mfma_f32_16x16x32_bf16 v[48:51], v[84:87], v[124:127], v[48:51]
    ds_read_b64_tr_b16 v[80:81], v228 offset:36864
    s_waitcnt vmcnt(0)
    v_mfma_f32_16x16x32_bf16 v[52:55], v[84:87], v[128:131], v[52:55]
    ds_read_b64_tr_b16 v[82:83], v228 offset:37376
    s_cbranch_scc0 L_SL4
    buffer_store_dword v8, v231, s[28:31], s59 offen
L_SB4:
    v_mfma_f32_16x16x32_bf16 v[56:59], v[84:87], v[132:135], v[56:59]
    v_mfma_f32_16x16x32_bf16 v[60:63], v[84:87], v[136:139], v[60:63]
    v_mfma_f32_16x16x32_bf16 v[64:67], v[84:87], v[140:143], v[64:67]
    v_mfma_f32_16x16x32_bf16 v[68:71], v[84:87], v[144:147], v[68:71]
    v_mfma_f32_16x16x32_bf16 v[72:75], v[84:87], v[148:151], v[72:75]
    v_mfma_f32_16x16x32_bf16 v[76:79], v[84:87], v[152:155], v[76:79]
    s_waitcnt lgkmcnt(2)
    v_mfma_f32_16x16x32_bf16 v[48:51], v[88:91], v[128:131], v[48:51]
    ds_read_b64_tr_b16 v[84:85], v228 offset:40960
    v_mfma_f32_16x16x32_bf16 v[52:55], v[88:91], v[132:135], v[52:55]
    ds_read_b64_tr_b16 v[86:87], v228 offset:41472
    v_mfma_f32_16x16x32_bf16 v[56:59], v[88:91], v[136:139], v[56:59]
    v_mfma_f32_16x16x32_bf16 v[60:63], v[88:91], v[140:143], v[60:63]
    v_mfma_f32_16x16x32_bf16 v[64:67], v[88:91], v[144:147], v[64:67]
    v_mfma_f32_16x16x32_bf16 v[68:71], v[88:91], v[148:151], v[68:71]
    v_mfma_f32_16x16x32_bf16 v[72:75], v[88:91], v[152:155], v[72:75]
    v_mfma_f32_16x16x32_bf16 v[76:79], v[88:91], v[156:159], v[76:79]
    s_waitcnt lgkmcnt(2)
    v_mfma_f32_16x16x32_bf16 v[48:51], v[80:83], v[132:135], v[48:51]
    ds_read_b64_tr_b16 v[88:89], v229 offset:0
    v_mfma_f32_16x16x32_bf16 v[52:55], v[80:83], v[136:139], v[52:55]
    ds_read_b64_tr_b16 v[90:91], v229 offset:512
    v_mfma_f32_16x16x32_bf16 v[56:59], v[80:83], v[140:143], v[56:59]
    v_mfma_f32_16x16x32_bf16 v[60:63], v[80:83], v[144:147], v[60:63]
    v_mfma_f32_16x16x32_bf16 v[64:67], v[80:83], v[148:151], v[64:67]
    v_mfma_f32_16x16x32_bf16 v[68:71], v[80:83], v[152:155], v[68:71]
    v_mfma_f32_16x16x32_bf16 v[72:75], v[80:83], v[156:159], v[72:75]
    v_mfma_f32_16x16x32_bf16 v[76:79], v[80:83], v[160:163], v[76:79]
    s_waitcnt lgkmcnt(2)
    v_mfma_f32_16x16x32_bf16 v[48:51], v[84:87], v[136:139], v[48:51]
    ds_read_b64_tr_b16 v[80:81], v229 offset:4096
    v_mfma_f32_16x16x32_bf16 v[52:55], v[84:87], v[140:143], v[52:55]
    ds_read_b64_tr_b16 v[82:83], v229 offset:4608
    v_mfma_f32_16x16x32_bf16 v[56:59], v[84:87], v[144:147], v[56:59]
    v_mfma_f32_16x16x32_bf16 v[60:63], v[84:87], v[148:151], v[60:63]
    v_mfma_f32_16x16x32_bf16 v[64:67], v[84:87], v[152:155], v[64:67]
    v_mfma_f32_16x16x32_bf16 v[68:71], v[84:87], v[156:159], v[68:71]
    v_mfma_f32_16x16x32_bf16 v[72:75], v[84:87], v[160:163], v[72:75]
    v_mfma_f32_16x16x32_bf16 v[76:79], v[84:87], v[164:167], v[76:79]
    s_waitcnt lgkmcnt(2)
    v_mfma_f32_16x16x32_bf16 v[48:51], v[88:91], v[140:143], v[48:51]
    ds_read_b64_tr_b16 v[84:85], v229 offset:8192
    v_mfma_f32_16x16x32_bf16 v[52:55], v[88:91], v[144:147], v[52:55]
L_LATE1:
    s_cbranch_execz L_PADRETT
    ds_read_b64_tr_b16 v[86:87], v229 offset:8704
    v_mfma_f32_16x16x32_bf16 v[56:59], v[88:91], v[148:151], v[56:59]
    ds_read_b64_tr_b16 v[196:197], v229 offset:12288
    v_mfma_f32_16x16x32_bf16 v[60:63], v[88:91], v[152:155], v[60:63]
    ds_read_b64_tr_b16 v[198:199], v229 offset:12800
    v_mfma_f32_16x16x32_bf16 v[64:67], v[88:91], v[156:159], v[64:67]
    v_mfma_f32_16x16x32_bf16 v[68:71], v[88:91], v[160:163], v[68:71]
    v_mfma_f32_16x16x32_bf16 v[72:75], v[88:91], v[164:167], v[72:75]
    v_mfma_f32_16x16x32_bf16 v[76:79], v[88:91], v[168:171], v[76:79]
    s_waitcnt lgkmcnt(4)
    v_mfma_f32_16x16x32_bf16 v[48:51], v[80:83], v[144:147], v[48:51]
    ds_read_b64_tr_b16 v[200:201], v229 offset:16384
    v_mfma_f32_16x16x32_bf16 v[52:55], v[80:83], v[148:151], v[52:55]
    ds_read_b64_tr_b16 v[202:203], v229 offset:16896
    v_mfma_f32_16x16x32_bf16 v[56:59], v[80:83], v[152:155], v[56:59]
    ds_read_b64_tr_b16 v[108:109], v229 offset:20480
    v_mfma_f32_16x16x32_bf16 v[60:63], v[80:83], v[156:159], v[60:63]
    ds_read_b64_tr_b16 v[110:111], v229 offset:20992
    v_mfma_f32_16x16x32_bf16 v[64:67], v[80:83], v[160:163], v[64:67]
    v_mfma_f32_16x16x32_bf16 v[68:71], v[80:83], v[164:167], v[68:71]
    v_mfma_f32_16x16x32_bf16 v[72:75], v[80:83], v[168:171], v[72:75]
    v_mfma_f32_16x16x32_bf16 v[76:79], v[80:83], v[172:175], v[76:79]
    s_waitcnt lgkmcnt(6)
    v_mfma_f32_16x16x32_bf16 v[48:51], v[84:87], v[148:151], v[48:51]
    ds_read_b64_tr_b16 v[112:113], v229 offset:24576
    v_mfma_f32_16x16x32_bf16 v[52:55], v[84:87], v[152:155], v[52:55]
    ds_read_b64_tr_b16 v[114:115], v229 offset:25088
    v_mfma_f32_16x16x32_bf16 v[56:59], v[84:87], v[156:159], v[56:59]
    v_mfma_f32_16x16x32_bf16 v[60:63], v[84:87], v[160:163], v[60:63]
    v_mfma_f32_16x16x32_bf16 v[64:67], v[84:87], v[164:167], v[64:67]
    v_mfma_f32_16x16x32_bf16 v[68:71], v[84:87], v[168:171], v[68:71]
    v_mfma_f32_16x16x32_bf16 v[72:75], v[84:87], v[172:175], v[72:75]
    v_mfma_f32_16x16x32_bf16 v[76:79], v[84:87], v[176:179], v[76:79]
    s_waitcnt lgkmcnt(0)
    v_mfma_f32_16x16x32_bf16 v[48:51], v[196:199], v[152:155], v[48:51]
    v_mfma_f32_16x16x32_bf16 v[52:55], v[196:199], v[156:159], v[52:55]
    s_barrier
    ds_read_b128 v[92:95], v232 offset:0
    ds_read_b128 v[96:99], v232 offset:1024
    ds_read_b128 v[100:103], v232 offset:2048
    ds_read_b128 v[104:107], v232 offset:3072
    v_mfma_f32_16x16x32_bf16 v[48:51], v[200:203], v[156:159], v[48:51]
    v_mfma_f32_16x16x32_bf16 v[52:55], v[200:203], v[160:163], v[52:55]
    v_mfma_f32_16x16x32_bf16 v[48:51], v[108:111], v[160:163], v[48:51]
    v_mfma_f32_16x16x32_bf16 v[52:55], v[108:111], v[164:167], v[52:55]
    v_mfma_f32_16x16x32_bf16 v[48:51], v[112:115], v[164:167], v[48:51]
    s_waitcnt lgkmcnt(3)
    v_lshlrev_b32 v16, 16, v92
    v_and_b32 v17, s27, v92
    v_mfma_f32_16x16x32_bf16 v[52:55], v[112:115], v[168:171], v[52:55]
    v_lshlrev_b32 v18, 16, v93
    v_and_b32 v19, s27, v93
    v_lshlrev_b32 v20, 16, v94
    v_mfma_f32_16x16x32_bf16 v[56:59], v[196:199], v[160:163], v[56:59]
    v_and_b32 v21, s27, v94
    v_lshlrev_b32 v22, 16, v95
    v_and_b32 v23, s27, v95
    v_mfma_f32_16x16x32_bf16 v[60:63], v[196:199], v[164:167], v[60:63]
    s_waitcnt lgkmcnt(2)
    v_pk_add_f32 v[16:17], v[16:17], v[48:49]
    v_pk_add_f32 v[18:19], v[18:19], v[50:51]
    v_mfma_f32_16x16x32_bf16 v[56:59], v[200:203], v[164:167], v[56:59]
    v_pk_add_f32 v[20:21], v[20:21], v[52:53]
    v_pk_add_f32 v[22:23], v[22:23], v[54:55]
    v_cvt_pk_bf16_f32 v116, v16, v17
    v_mfma_f32_16x16x32_bf16 v[60:63], v[200:203], v[168:171], v[60:63]
    v_cvt_pk_bf16_f32 v117, v18, v19
    v_cvt_pk_bf16_f32 v118, v20, v21
    v_cvt_pk_bf16_f32 v119, v22, v23
    v_mfma_f32_16x16x32_bf16 v[56:59], v[108:111], v[168:171], v[56:59]
    s_cbranch_scc0 L_SL5
L_LATE2:
    s_cbranch_execz L_PADRETT
    buffer_store_dwordx4 v[116:119], v6, s[28:31], s55 offen offset:0
L_SB5:
    v_lshlrev_b32 v24, 16, v96
    v_and_b32 v25, s27, v96
    v_mfma_f32_16x16x32_bf16 v[60:63], v[108:111], v[172:175], v[60:63]
    v_lshlrev_b32 v26, 16, v97
    v_and_b32 v27, s27, v97
    v_lshlrev_b32 v28, 16, v98
    v_mfma_f32_16x16x32_bf16 v[56:59], v[112:115], v[172:175], v[56:59]
    v_and_b32 v29, s27, v98
    v_lshlrev_b32 v30, 16, v99
    v_and_b32 v31, s27, v99
    v_mfma_f32_16x16x32_bf16 v[60:63], v[112:115], v[176:179], v[60:63]
    s_waitcnt lgkmcnt(1)
    v_lshlrev_b32 v32, 16, v100
    v_and_b32 v33, s27, v100
    v_mfma_f32_16x16x32_bf16 v[64:67], v[196:199], v[168:171], v[64:67]
    v_lshlrev_b32 v34, 16, v101
    v_and_b32 v35, s27, v101
    v_lshlrev_b32 v36, 16, v102
    v_mfma_f32_16x16x32_bf16 v[68:71], v[196:199], v[172:175], v[68:71]
    v_and_b32 v37, s27, v102
    v_pk_add_f32 v[24:25], v[24:25], v[56:57]
    v_pk_add_f32 v[26:27], v[26:27], v[58:59]
    v_mfma_f32_16x16x32_bf16 v[64:67], v[200:203], v[172:175], v[64:67]
    v_pk_add_f32 v[28:29], v[28:29], v[60:61]
    v_pk_add_f32 v[30:31], v[30:31], v[62:63]
    v_cvt_pk_bf16_f32 v120, v24, v25
    v_mfma_f32_16x16x32_bf16 v[68:71], v[200:203], v[176:179], v[68:71]
    v_cvt_pk_bf16_f32 v121, v26, v27
    v_cvt_pk_bf16_f32 v122, v28, v29
    v_cvt_pk_bf16_f32 v123, v30, v31
    v_mfma_f32_16x16x32_bf16 v[64:67], v[108:111], v[176:179], v[64:67]
    s_cbranch_scc0 L_SL6
    buffer_store_dwordx4 v[120:123], v6, s[28:31], s55 offen offset:256
L_SB6:
    v_lshlrev_b32 v38, 16, v103
    v_and_b32 v39, s27, v103
    v_mfma_f32_16x16x32_bf16 v[68:71], v[108:111], v[180:183], v[68:71]
    s_waitcnt lgkmcnt(0)
    v_lshlrev_b32 v40, 16, v104
    v_and_b32 v41, s27, v104
    v_mfma_f32_16x16x32_bf16 v[64:67], v[112:115], v[180:183], v[64:67]
    v_lshlrev_b32 v42, 16, v105
    v_and_b32 v43, s27, v105
    v_lshlrev_b32 v44, 16, v106
    v_mfma_f32_16x16x32_bf16 v[68:71], v[112:115], v[184:187], v[68:71]
    v_and_b32 v45, s27, v106
    v_lshlrev_b32 v46, 16, v107
    v_and_b32 v47, s27, v107
    v_mfma_f32_16x16x32_bf16 v[72:75], v[196:199], v[176:179], v[72:75]
    s_nop 1
    v_mfma_f32_16x16x32_bf16 v[76:79], v[196:199], v[180:183], v[76:79]
    s_nop 1
    v_mfma_f32_16x16x32_bf16 v[72:75], v[200:203], v[180:183], v[72:75]
    v_pk_add_f32 v[32:33], v[32:33], v[64:65]
    v_pk_add_f32 v[34:35], v[34:35], v[66:67]
    v_pk_add_f32 v[36:37], v[36:37], v[68:69]
    v_mfma_f32_16x16x32_bf16 v[76:79], v[200:203], v[184:187], v[76:79]
    v_pk_add_f32 v[38:39], v[38:39], v[70:71]
    v_cvt_pk_bf16_f32 v124, v32, v33
    v_cvt_pk_bf16_f32 v125, v34, v35
    v_mfma_f32_16x16x32_bf16 v[72:75], v[108:111], v[184:187], v[72:75]
    v_cvt_pk_bf16_f32 v126, v36, v37
    v_cvt_pk_bf16_f32 v127, v38, v39
    s_cbranch_scc0 L_SL7
    buffer_store_dwordx4 v[124:127], v6, s[28:31], s55 offen offset:512
L_SB7:
    v_mfma_f32_16x16x32_bf16 v[76:79], v[108:111], v[188:191], v[76:79]
    v_mfma_f32_16x16x32_bf16 v[72:75], v[112:115], v[188:191], v[72:75]
    v_mfma_f32_16x16x32_bf16 v[76:79], v[112:115], v[192:195], v[76:79]
    s_nop 1
    s_nop 6
    v_pk_add_f32 v[40:41], v[40:41], v[72:73]
    v_pk_add_f32 v[42:43], v[42:43], v[74:75]
    v_pk_add_f32 v[44:45], v[44:45], v[76:77]
    v_pk_add_f32 v[46:47], v[46:47], v[78:79]
    v_cvt_pk_bf16_f32 v128, v40, v41
    v_cvt_pk_bf16_f32 v129, v42, v43
    v_cvt_pk_bf16_f32 v130, v44, v45
    v_cvt_pk_bf16_f32 v131, v46, v47
    s_cbranch_scc0 L_SL8
    buffer_store_dwordx4 v[128:131], v6, s[28:31], s55 offen offset:768
L_SB8:
L_LATE3:
    s_cbranch_execz L_PADRETT
    s_barrier
    s_waitcnt vmcnt(0)
    s_cbranch_scc0 L_SL9
    buffer_store_dword v8, v9, s[28:31], s62 offen
L_SB9:
L_POLL:
    buffer_load_dword v15, v3, s[28:31], s60 offen sc1
    s_sub_u32 s63, s63, 1
    s_waitcnt vmcnt(0)
    v_cmp_ne_u32 vcc, 1, v15
    s_cmp_eq_u64 vcc, 0
    s_cbranch_scc0 L_POLLMORE
L_GOT:
    buffer_load_dwordx4 v[48:51], v1, s[28:31], s56 offen sc1
    buffer_load_dwordx4 v[52:55], v1, s[28:31], s57 offen sc1
    s_waitcnt vmcnt(1)
    v_lshlrev_b32 v16, 16, v48
    v_and_b32 v17, s27, v48
    v_lshlrev_b32 v18, 16, v49
    v_and_b32 v19, s27, v49
    v_lshlrev_b32 v20, 16, v50
    v_and_b32 v21, s27, v50
    v_lshlrev_b32 v22, 16, v51
    v_and_b32 v23, s27, v51
    s_waitcnt vmcnt(0)
    v_lshlrev_b32 v24, 16, v52
    v_and_b32 v25, s27, v52
    v_lshlrev_b32 v26, 16, v53
    v_and_b32 v27, s27, v53
    v_lshlrev_b32 v28, 16, v54
    v_and_b32 v29, s27, v54
    v_lshlrev_b32 v30, 16, v55
    v_and_b32 v31, s27, v55
    v_pk_add_f32 v[16:17], v[16:17], v[24:25]
    v_pk_add_f32 v[18:19], v[18:19], v[26:27]
    v_pk_add_f32 v[20:21], v[20:21], v[28:29]
    v_pk_add_f32 v[22:23], v[22:23], v[30:31]
    s_nop 1
    v_permlane32_swap_b32 v16, v20
    v_permlane32_swap_b32 v17, v21
    v_permlane32_swap_b32 v18, v22
    v_permlane32_swap_b32 v19, v23
    v_pk_add_f32 v[16:17], v[16:17], v[20:21]
    v_pk_add_f32 v[18:19], v[18:19], v[22:23]
    v_pk_add_f32 v[16:17], v[16:17], s[4:5]
    v_pk_add_f32 v[18:19], v[18:19], s[6:7]
    v_cndmask_b32 v20, 0, v16, s[24:25]
    v_cndmask_b32 v21, 0, v17, s[24:25]
    v_cndmask_b32 v22, 0, v18, s[24:25]
    v_cndmask_b32 v23, 0, v19, s[24:25]
    v_pk_mul_f32 v[24:25], v[20:21], v[20:21]
    v_pk_mul_f32 v[26:27], v[22:23], v[22:23]
    v_permlane32_swap_b32 v20, v22
    v_permlane32_swap_b32 v21, v23
    v_permlane32_swap_b32 v24, v26
    v_permlane32_swap_b32 v25, v27
    v_add_f32 v20, v20, v22
    v_add_f32 v21, v21, v23
    v_add_f32 v24, v24, v26
    v_add_f32 v25, v25, v27
    s_nop 0
    v_permlane16_swap_b32 v20, v21
    v_permlane16_swap_b32 v24, v25
    v_add_f32 v20, v20, v21
    v_add_f32 v24, v24, v25
    s_nop 0
    v_add_f32_dpp v28, v20, v20 row_ror:8 row_mask:0xf bank_mask:0x3
    v_add_f32_dpp v28, v24, v24 row_ror:8 row_mask:0xf bank_mask:0xc
    s_nop 1
    v_add_f32_dpp v28, v28, v28 row_half_mirror row_mask:0xf bank_mask:0xf
    s_nop 1
    v_add_f32_dpp v28, v28, v28 quad_perm:[1,0,3,2] row_mask:0xf bank_mask:0xf
    s_nop 1
    v_add_f32_dpp v28, v28, v28 quad_perm:[2,3,0,1] row_mask:0xf bank_mask:0xf
    ds_write_b32 v4, v28
    s_waitcnt lgkmcnt(0)
    s_barrier
    ds_read_b32 v28, v5
    s_waitcnt lgkmcnt(0)
    v_mul_f32 v28, s26, v28
    s_nop 1
    v_add_f32_dpp v28, v28, v28 row_half_mirror row_mask:0xf bank_mask:0xf
    s_nop 1
    v_add_f32_dpp v28, v28, v28 quad_perm:[1,0,3,2] row_mask:0xf bank_mask:0xf
    s_nop 1
    v_add_f32_dpp v28, v28, v28 quad_perm:[2,3,0,1] row_mask:0xf bank_mask:0xf
    s_nop 1
    v_mov_b32_dpp v29, v28 row_ror:8 row_mask:0xf bank_mask:0xf
    v_fma_f32 v29, -v28, v28, v29
    v_max_f32 v29, 0, v29
    v_add_f32 v29, 0x3727c5ac, v29
    v_rsq_f32 v29, v29
    s_nop 0
    v_mul_f32 v29, v11, v29
    v_fma_f32 v28, -v28, v29, v14
    v_readlane_b32 s48, v29, 0
    v_readlane_b32 s49, v29, 16
L_LATE4:
    s_cbranch_execz L_PADRETT
    v_readlane_b32 s50, v29, 32
    v_readlane_b32 s51, v29, 48
    v_readlane_b32 s52, v28, 0
    v_readlane_b32 s53, v28, 16
    v_readlane_b32 s54, v28, 32
    v_readlane_b32 s55, v28, 48
    v_pk_mul_f32 v[16:17], v[16:17], s[48:49]
    v_pk_mul_f32 v[18:19], v[18:19], s[50:51]
    v_pk_add_f32 v[16:17], v[16:17], s[52:53]
    v_pk_add_f32 v[18:19], v[18:19], s[54:55]
    v_pk_mul_f32 v[20:21], v[16:17], v[16:17]
    v_pk_mul_f32 v[22:23], v[18:19], v[18:19]
    v_pk_fma_f32 v[20:21], v[20:21], s[20:21], v[12:13]
    v_pk_fma_f32 v[22:23], v[22:23], s[20:21], v[12:13]
    v_pk_mul_f32 v[20:21], v[20:21], v[16:17]
    v_pk_mul_f32 v[22:23], v[22:23], v[18:19]
    v_exp_f32 v20, v20
    v_exp_f32 v21, v21
    v_exp_f32 v22, v22
    v_exp_f32 v23, v23
    s_nop 0
    v_pk_add_f32 v[20:21], v[20:21], s[22:23]
    v_pk_add_f32 v[22:23], v[22:23], s[22:23]
    v_rcp_f32 v20, v20
    v_rcp_f32 v21, v21
    v_rcp_f32 v22, v22
    v_rcp_f32 v23, v23
    s_nop 0
    v_pk_mul_f32 v[16:17], v[16:17], v[20:21]
    v_pk_mul_f32 v[18:19], v[18:19], v[22:23]
    v_cvt_pk_bf16_f32 v20, v16, v17
    v_cvt_pk_bf16_f32 v21, v18, v19
    s_and_saveexec_b64 s[26:27], s[24:25]
    s_cbranch_execz L_FIN
    buffer_store_dwordx2 v[20:21], v2, s[36:39], 0 offen
L_FIN:
    s_endpgm
L_POLLMORE:
    s_cmp_eq_u32 s63, 0
    s_cbranch_scc1 L_GOT
    s_cmp_eq_u32 s61, 1
    s_cbranch_scc1 L_POLL
    s_sleep 8
    s_branch L_POLL
L_SL0:
    buffer_store_dwordx4 v[204:207], v230, s[28:31], s58 offen offset:0 sc1
    s_branch L_SB0
L_SL1:
    buffer_store_dwordx4 v[208:211], v230, s[28:31], s58 offen offset:1024 sc1
    s_branch L_SB1
L_SL2:
    buffer_store_dwordx4 v[212:215], v230, s[28:31], s58 offen offset:2048 sc1
    s_branch L_SB2
L_SL3:
    buffer_store_dwordx4 v[216:219], v230, s[28:31], s58 offen offset:3072 sc1
    s_branch L_SB3
L_SL4:
    buffer_store_dword v8, v231, s[28:31], s59 offen sc1
    s_branch L_SB4
L_SL5:
    buffer_store_dwordx4 v[116:119], v6, s[28:31], s55 offen offset:0 sc1
    s_branch L_SB5
L_SL6:
    buffer_store_dwordx4 v[120:123], v6, s[28:31], s55 offen offset:256 sc1
    s_branch L_SB6
L_SL7:
    buffer_store_dwordx4 v[124:127], v6, s[28:31], s55 offen offset:512 sc1
    s_branch L_SB7
L_SL8:
    buffer_store_dwordx4 v[128:131], v6, s[28:31], s55 offen offset:768 sc1
    s_branch L_SB8
L_SL9:
    buffer_store_dword v8, v9, s[28:31], s62 offen sc1
    s_branch L_SB9
L_LOADLOOP:
    s_mov_b32 s4, s60
    s_mov_b32 s5, s61
    s_mov_b32 s28, s18
    s_and_b32 s29, s19, 0xffff
    s_mov_b32 s30, 12599296
    s_mov_b32 s31, 0x20000
    s_mov_b32 s36, s14
    s_and_b32 s37, s15, 0xffff
    s_mov_b32 s38, 993280
    s_mov_b32 s39, 0x20000
    s_lshl_b32 s58, s46, 10
    s_add_u32 s58, s58, 12582912
    v_mov_b32 v40, 0
    v_mov_b32 v41, 0
    v_mov_b32 v42, 0
    v_mov_b32 v43, 0
    v_lshlrev_b32 v49, 4, v17
    s_cmp_eq_u32 s47, 0
    s_cselect_b32 s55, 2, 1
    s_cmp_eq_u32 s40, 4
    s_cselect_b32 s55, s55, 0
    s_cmp_eq_u32 s55, 2
    s_cbranch_scc0 L_NORESET
    buffer_store_dwordx4 v[40:43], v49, s[28:31], s58 offen sc1
L_NORESET:
L_PAD19:
    s_cbranch_execz L_PADRETC
    s_lshl_b32 s48, s42, 7
    s_lshl_b32 s49, s47, 3
    s_add_u32 s48, s48, s49
    s_load_dwordx2 s[8:9], s[8:9], s48
    s_load_dwordx2 s[10:11], s[10:11], s48
    s_load_dwordx2 s[12:13], s[12:13], s48
    s_mov_b32 s32, s16
    s_and_b32 s33, s17, 0xffff
    s_mov_b32 s34, 256
    s_mov_b32 s35, 0x20000
    s_lshl_b32 s62, s46, 4
    s_add_u32 s62, s62, s47
    s_lshl_b32 s62, s62, 14
    s_lshl_b32 s60, s46, 4
    v_lshlrev_b32 v42, 7, v17
    s_lshl_b32 s57, s45, 12
    s_add_u32 s57, s57, s62
    s_getreg_b32 s48, hwreg(HW_REG_XCC_ID, 0, 4)
    s_or_b32 s48, s48, 0x10
    v_mov_b32 v41, s48
    s_lshl_b32 s59, s47, 2
    s_add_u32 s59, s59, s58
    v_and_b32 v50, 15, v17
    v_lshlrev_b32 v50, 2, v50
    s_mov_b64 exec, 0
    s_cmp_eq_u32 s45, 0
    s_cbranch_scc1 L_PAD2
    s_cmp_eq_u32 s45, 1
    s_cbranch_scc1 L_PAD4
    s_cmp_eq_u32 s45, 2
    s_cbranch_scc1 L_PAD6
    s_cmp_eq_u32 s45, 3
    s_cbranch_scc1 L_PAD8
L_PADRETL:
    s_mov_b64 exec, -1
    s_waitcnt vmcnt(5)
    s_barrier
    s_add_u32 m0, s54, 16384
    s_mov_b32 s48, 4194304
    buffer_load_dwordx4 v26, s[24:27], s48 offen lds
    s_add_u32 m0, s54, 20480
    s_mov_b32 s48, 5242880
    buffer_load_dwordx4 v26, s[24:27], s48 offen lds
    s_add_u32 m0, s54, 24576
    s_mov_b32 s48, 6291456
    buffer_load_dwordx4 v26, s[24:27], s48 offen lds
    s_add_u32 m0, s54, 28672
    s_mov_b32 s48, 7340032
    buffer_load_dwordx4 v26, s[24:27], s48 offen lds
    s_add_u32 m0, s54, 32768
    s_mov_b32 s48, 8388608
    buffer_load_dwordx4 v26, s[24:27], s48 offen lds
    s_add_u32 m0, s54, 36864
    s_mov_b32 s48, 9437184
    buffer_load_dwordx4 v26, s[24:27], s48 offen lds
    s_waitcnt vmcnt(6)
    s_barrier
    s_add_u32 m0, s54, 40960
    s_mov_b32 s48, 10485760
    buffer_load_dwordx4 v26, s[24:27], s48 offen lds
    s_add_u32 m0, s54, 45056
    s_mov_b32 s48, 11534336
    buffer_load_dwordx4 v26, s[24:27], s48 offen lds
    s_add_u32 m0, s51, 34816
    s_add_u32 s48, s50, 1024
    s_max_i32 s48, s48, 0
    buffer_load_dwordx4 v20, s[20:23], s48 offen lds
    s_waitcnt vmcnt(7)
    s_barrier
    s_add_u32 m0, s54, 49152
    s_mov_b32 s48, 12582912
    buffer_load_dwordx4 v26, s[24:27], s48 offen lds
    s_add_u32 m0, s54, 53248
    s_mov_b32 s48, 13631488
    buffer_load_dwordx4 v26, s[24:27], s48 offen lds
    s_add_u32 m0, s51, 35840
    s_add_u32 s48, s50, 17408
    buffer_load_dwordx4 v20, s[20:23], s48 offen lds
    s_cmp_eq_u32 s55, 2
    s_cbranch_scc0 L_NORDY
    s_waitcnt vmcnt(12)
    s_mov_b64 exec, 1
    buffer_store_dword v41, v40, s[32:35], s60 offen sc1
    s_mov_b64 exec, -1
L_NORDY:
L_PAD20:
    s_cbranch_execz L_PADRETL
    s_waitcnt vmcnt(8)
    s_barrier
    s_add_u32 m0, s54, 57344
    s_mov_b32 s48, 14680064
    buffer_load_dwordx4 v26, s[24:27], s48 offen lds
    s_add_u32 m0, s54, 61440
    s_mov_b32 s48, 15728640
    buffer_load_dwordx4 v26, s[24:27], s48 offen lds
    s_add_u32 m0, s51, 43008
    s_add_u32 s48, s50, 132096
    buffer_load_dwordx4 v21, s[20:23], s48 offen lds
    s_waitcnt vmcnt(9)
    s_barrier
    s_add_u32 m0, s54, 65536
    s_mov_b32 s48, 0
    buffer_load_dwordx4 v27, s[24:27], s48 offen lds
    s_add_u32 m0, s54, 69632
    s_mov_b32 s48, 1048576
    buffer_load_dwordx4 v27, s[24:27], s48 offen lds
    s_add_u32 m0, s51, 44032
    s_add_u32 s48, s50, 148480
    buffer_load_dwordx4 v21, s[20:23], s48 offen lds
    s_waitcnt vmcnt(10)
    s_barrier
    s_add_u32 m0, s54, 73728
    s_mov_b32 s48, 2097152
    buffer_load_dwordx4 v27, s[24:27], s48 offen lds
    s_add_u32 m0, s54, 77824
    s_mov_b32 s48, 3145728
    buffer_load_dwordx4 v27, s[24:27], s48 offen lds
    s_add_u32 m0, s5, 34816
    s_add_u32 s48, s4, 1024
    s_max_i32 s48, s48, 0
    buffer_load_dwordx4 v20, s[20:23], s48 offen lds
    s_cmp_eq_u32 s55, 0
    s_cbranch_scc1 L_NORL
    s_mov_b64 exec, 1
    buffer_load_dword v44, v40, s[32:35], s60 offen sc1
    s_mov_b64 exec, -1
L_NORL:
    s_waitcnt vmcnt(10)
    s_barrier
    s_add_u32 m0, s54, 81920
    s_mov_b32 s48, 4194304
    buffer_load_dwordx4 v27, s[24:27], s48 offen lds
    s_add_u32 m0, s54, 86016
    s_mov_b32 s48, 5242880
    buffer_load_dwordx4 v27, s[24:27], s48 offen lds
    s_add_u32 m0, s5, 35840
    s_add_u32 s48, s4, 17408
    buffer_load_dwordx4 v20, s[20:23], s48 offen lds
    s_waitcnt vmcnt(10)
    s_barrier
    s_add_u32 m0, s54, 0
    s_mov_b32 s48, 6291456
    buffer_load_dwordx4 v27, s[24:27], s48 offen lds
    s_add_u32 m0, s54, 4096
    s_mov_b32 s48, 7340032
    buffer_load_dwordx4 v27, s[24:27], s48 offen lds
    s_add_u32 m0, s54, 8192
    s_mov_b32 s48, 8388608
    buffer_load_dwordx4 v27, s[24:27], s48 offen lds
    s_add_u32 m0, s5, 43008
    s_add_u32 s48, s4, 132096
    buffer_load_dwordx4 v21, s[20:23], s48 offen lds
    s_waitcnt vmcnt(11)
    s_barrier
    s_add_u32 m0, s54, 12288
    s_mov_b32 s48, 9437184
    buffer_load_dwordx4 v27, s[24:27], s48 offen lds
    s_add_u32 m0, s54, 16384
    s_mov_b32 s48, 10485760
    buffer_load_dwordx4 v27, s[24:27], s48 offen lds
    s_add_u32 m0, s54, 20480
L_PAD21:
    s_cbranch_execz L_PADRETC
    s_mov_b32 s48, 11534336
    buffer_load_dwordx4 v27, s[24:27], s48 offen lds
    s_add_u32 m0, s5, 44032
    s_add_u32 s48, s4, 148480
    buffer_load_dwordx4 v21, s[20:23], s48 offen lds
    s_waitcnt vmcnt(12)
    s_barrier
    s_add_u32 m0, s54, 24576
    s_mov_b32 s48, 12582912
    buffer_load_dwordx4 v27, s[24:27], s48 offen lds
    s_add_u32 m0, s54, 28672
    s_mov_b32 s48, 13631488
    buffer_load_dwordx4 v27, s[24:27], s48 offen lds
    s_add_u32 m0, s54, 32768
    s_mov_b32 s48, 14680064
    buffer_load_dwordx4 v27, s[24:27], s48 offen lds
    s_add_u32 m0, s53, 34816
    s_add_u32 s48, s52, 1024
    buffer_load_dwordx4 v22, s[20:23], s48 offen lds
    s_cmp_eq_u32 s55, 0
    s_cbranch_scc1 L_NOXCC
    s_waitcnt vmcnt(15)
    s_mov_b32 s63, 40000
L_RCHK:
    v_readfirstlane_b32 s48, v44
    s_cmp_lg_u32 s48, 0
    s_cbranch_scc1 L_ROK
    s_sub_u32 s63, s63, 1
    s_cmp_eq_u32 s63, 0
    s_cbranch_scc1 L_ROK
    s_sleep 4
    s_mov_b64 exec, 1
    buffer_load_dword v44, v40, s[32:35], s60 offen sc1
    s_mov_b64 exec, -1
    s_waitcnt vmcnt(0)
    s_branch L_RCHK
L_ROK:
    s_mov_b64 exec, 1
    buffer_store_dword v41, v40, s[28:31], s59 offen offset:256 sc1
    s_mov_b64 exec, -1
L_NOXCC:
    s_waitcnt vmcnt(13)
    s_barrier
    s_add_u32 m0, s54, 36864
    s_mov_b32 s48, 15728640
    buffer_load_dwordx4 v27, s[24:27], s48 offen lds
    s_add_u32 m0, s54, 40960
    s_mov_b32 s48, 524288
    buffer_load_dwordx4 v26, s[24:27], s48 offen lds
    s_add_u32 m0, s54, 45056
    s_mov_b32 s48, 1572864
    buffer_load_dwordx4 v26, s[24:27], s48 offen lds
    s_waitcnt vmcnt(13)
    s_barrier
    s_add_u32 m0, s54, 49152
    s_mov_b32 s48, 2621440
    buffer_load_dwordx4 v26, s[24:27], s48 offen lds
    s_add_u32 m0, s54, 53248
    s_mov_b32 s48, 3670016
    buffer_load_dwordx4 v26, s[24:27], s48 offen lds
    s_add_u32 m0, s54, 57344
    s_mov_b32 s48, 4718592
    buffer_load_dwordx4 v26, s[24:27], s48 offen lds
    s_waitcnt vmcnt(13)
    s_barrier
    s_add_u32 m0, s54, 61440
    s_mov_b32 s48, 5767168
    buffer_load_dwordx4 v26, s[24:27], s48 offen lds
    s_add_u32 m0, s54, 65536
    s_mov_b32 s48, 6815744
    buffer_load_dwordx4 v26, s[24:27], s48 offen lds
    s_add_u32 m0, s54, 69632
    s_mov_b32 s48, 7864320
    buffer_load_dwordx4 v26, s[24:27], s48 offen lds
    s_waitcnt vmcnt(9)
    s_barrier
    s_add_u32 m0, s54, 73728
    s_mov_b32 s48, 8912896
    buffer_load_dwordx4 v26, s[24:27], s48 offen lds
    s_add_u32 m0, s54, 77824
L_PAD22:
    s_cbranch_execz L_PADRETL
    s_mov_b32 s48, 9961472
    buffer_load_dwordx4 v26, s[24:27], s48 offen lds
    s_add_u32 m0, s54, 81920
    s_mov_b32 s48, 11010048
    buffer_load_dwordx4 v26, s[24:27], s48 offen lds
    s_cmp_eq_u32 s55, 0
    s_cbranch_scc1 L_NOCHK
    buffer_load_dword v44, v50, s[28:31], s58 offen offset:256 sc1
L_NOCHK:
    s_waitcnt vmcnt(14)
    s_barrier
    s_add_u32 m0, s54, 86016
    s_mov_b32 s48, 12058624
    buffer_load_dwordx4 v26, s[24:27], s48 offen lds
    s_add_u32 m0, s54, 0
    s_mov_b32 s48, 13107200
    buffer_load_dwordx4 v26, s[24:27], s48 offen lds
    s_add_u32 m0, s54, 4096
    s_mov_b32 s48, 14155776
    buffer_load_dwordx4 v26, s[24:27], s48 offen lds
    s_waitcnt vmcnt(14)
    s_barrier
    s_add_u32 m0, s54, 8192
    s_mov_b32 s48, 15204352
    buffer_load_dwordx4 v26, s[24:27], s48 offen lds
    s_add_u32 m0, s54, 12288
    s_mov_b32 s48, 524288
    buffer_load_dwordx4 v27, s[24:27], s48 offen lds
    s_add_u32 m0, s54, 16384
    s_mov_b32 s48, 1572864
    buffer_load_dwordx4 v27, s[24:27], s48 offen lds
    s_waitcnt vmcnt(15)
    s_barrier
    s_add_u32 m0, s54, 20480
    s_mov_b32 s48, 2621440
    buffer_load_dwordx4 v27, s[24:27], s48 offen lds
    s_add_u32 m0, s54, 24576
    s_mov_b32 s48, 3670016
    buffer_load_dwordx4 v27, s[24:27], s48 offen lds
    s_add_u32 m0, s54, 28672
    s_mov_b32 s48, 4718592
    buffer_load_dwordx4 v27, s[24:27], s48 offen lds
    s_waitcnt vmcnt(16)
    s_barrier
    s_add_u32 m0, s54, 32768
    s_mov_b32 s48, 5767168
    buffer_load_dwordx4 v27, s[24:27], s48 offen lds
    s_add_u32 m0, s54, 36864
    s_mov_b32 s48, 6815744
    buffer_load_dwordx4 v27, s[24:27], s48 offen lds
    s_add_u32 m0, s54, 40960
    s_mov_b32 s48, 7864320
    buffer_load_dwordx4 v27, s[24:27], s48 offen lds
    s_cmp_eq_u32 s55, 0
    s_cbranch_scc1 L_NOMODE
    s_waitcnt vmcnt(12)
    s_mov_b32 s63, 40000
L_HCHK:
    v_cmp_eq_u32 vcc, 0, v44
    s_cmp_eq_u64 vcc, 0
    s_cbranch_scc1 L_HOK
    s_sub_u32 s63, s63, 1
    s_cmp_eq_u32 s63, 0
    s_cbranch_scc1 L_HOK
    s_sleep 4
    buffer_load_dword v44, v50, s[28:31], s58 offen offset:256 sc1
    s_waitcnt vmcnt(0)
    s_branch L_HCHK
L_HOK:
    v_cmp_ne_u32 vcc, v41, v44
    s_cmp_eq_u64 vcc, 0
    s_cselect_b32 s61, 1, 0
    v_mov_b32 v45, s61
    v_mov_b32 v46, 159744
    ds_write_b32 v46, v45
    s_waitcnt lgkmcnt(0)
L_NOMODE:
    s_waitcnt vmcnt(17)
    s_barrier
    s_add_u32 m0, s54, 45056
    s_mov_b32 s48, 8912896
    buffer_load_dwordx4 v27, s[24:27], s48 offen lds
L_PAD23:
    s_cbranch_execz L_PADRETC
    s_add_u32 m0, s54, 49152
    s_mov_b32 s48, 9961472
    buffer_load_dwordx4 v27, s[24:27], s48 offen lds
    s_add_u32 m0, s54, 53248
    s_mov_b32 s48, 11010048
    buffer_load_dwordx4 v27, s[24:27], s48 offen lds
    v_mov_b32 v46, 159744
    ds_read_b32 v45, v46
    s_waitcnt lgkmcnt(0)
    v_readfirstlane_b32 s61, v45
    s_and_b32 s49, s61, s55
    s_cmp_eq_u32 s49, 1
    s_cbranch_scc0 L_NOFT
    s_mov_b64 exec, 0xff
    buffer_load_dword v43, v42, s[28:31], s58 offen
    s_mov_b64 exec, -1
L_NOFT:
    s_waitcnt vmcnt(18)
    s_barrier
    s_add_u32 m0, s54, 57344
    s_mov_b32 s48, 12058624
    buffer_load_dwordx4 v27, s[24:27], s48 offen lds
    s_add_u32 m0, s54, 61440
    s_mov_b32 s48, 13107200
    buffer_load_dwordx4 v27, s[24:27], s48 offen lds
    s_mov_b32 exec_hi, 0
    s_xor_b32 s48, s57, 16384
    buffer_load_dword v48, v42, s[28:31], s48 offen
    s_mov_b64 exec, -1
    s_waitcnt vmcnt(19)
    s_barrier
    s_add_u32 m0, s54, 65536
    s_mov_b32 s48, 14155776
    buffer_load_dwordx4 v27, s[24:27], s48 offen lds
    s_add_u32 m0, s54, 69632
    s_mov_b32 s48, 15204352
    buffer_load_dwordx4 v27, s[24:27], s48 offen lds
    s_waitcnt vmcnt(19)
    s_barrier
    s_waitcnt vmcnt(17)
    s_barrier
    s_waitcnt vmcnt(12)
    s_barrier
    s_waitcnt vmcnt(7)
    s_barrier
    s_waitcnt vmcnt(0)
    s_barrier
    s_cmp_eq_u32 s61, 1
    s_cselect_b32 s48, 0, 4194304
    s_add_u32 s62, s57, s48
    s_lshl_b32 s59, s47, 5
    s_add_u32 s59, s59, s58
    s_lshl_b32 s48, s45, 3
    s_add_u32 s59, s59, s48
    v_and_b32 v50, 1, v17
    v_lshlrev_b32 v50, 2, v50
    s_lshl_b32 s54, s45, 12
    s_mov_b64 exec, 0
    s_cmp_eq_u32 s45, 0
    s_cbranch_scc1 L_LATE0
    s_cmp_eq_u32 s45, 1
    s_cbranch_scc1 L_LATE1
    s_cmp_eq_u32 s45, 2
    s_cbranch_scc1 L_LATE2
    s_cmp_eq_u32 s45, 3
    s_cbranch_scc1 L_LATE3
L_PADRETT:
    s_mov_b64 exec, -1
    s_lshl_b32 s56, s46, 4
    s_lshr_b32 s49, s40, 2
    s_lshl_b32 s49, s49, 3
    s_add_u32 s56, s56, s49
    s_bfe_u32 s49, s40, 0x10001
    s_add_u32 s56, s56, s49
    s_lshl_b32 s56, s56, 14
    s_lshl_b32 s49, s47, 10
    s_add_u32 s56, s56, s49
    s_lshl_b32 s60, s46, 10
    s_add_u32 s60, s60, 12582912
    s_lshr_b32 s49, s47, 2
    s_lshl_b32 s49, s49, 6
    s_add_u32 s60, s60, s49
    s_lshr_b32 s49, s40, 1
    s_lshl_b32 s49, s49, 4
    s_add_u32 s60, s60, s49
    v_and_b32 v3, 7, v0
    v_lshlrev_b32 v24, 5, v3
    v_and_b32 v3, 3, v0
    v_lshlrev_b32 v3, 2, v3
    v_bfe_u32 v15, v0, 5, 1
    v_and_b32 v1, 31, v0
    v_lshlrev_b32 v1, 4, v1
    v_lshl_add_u32 v1, v15, 16, v1
    s_and_b32 s49, s40, 1
    s_lshl_b32 s49, s49, 9
    v_add_u32 v1, s49, v1
    v_and_b32 v2, 15, v0
    v_lshl_add_u32 v2, v2, 4, v15
    v_bfe_u32 v15, v0, 4, 1
L_PAD24:
    s_cbranch_execz L_PADRETL
    v_lshl_add_u32 v2, v15, 1, v2
    s_lshr_b32 s49, s40, 2
    s_lshl_b32 s49, s49, 8
    s_xor_b32 s48, s45, 2
    s_lshl_b32 s48, s48, 2
    s_add_u32 s49, s49, s48
    v_add_u32 v2, s49, v2
    s_movk_i32 s49, 485
    v_cmp_gt_u32 s[24:25], s49, v2
    s_mul_i32 s49, s43, 485
    v_add_u32 v2, s49, v2
    v_lshlrev_b32 v2, 10, v2
    s_lshl_b32 s48, s42, 7
    s_lshl_b32 s49, s47, 3
    s_add_u32 s48, s48, s49
    v_add_u32 v2, s48, v2
    v_lshrrev_b32 v4, 3, v0
    v_lshlrev_b32 v4, 2, v4
    v_add_u32 v4, 160000, v4
    v_bfe_u32 v15, v0, 3, 3
    v_lshl_add_u32 v5, v15, 2, v24
    v_add_u32 v5, 160000, v5
    v_mov_b32 v12, 0xc0135761
    v_mov_b32 v13, 0xc0135761
    s_mov_b32 s20, 0xbdd2d3e8
    s_mov_b32 s21, 0xbdd2d3e8
    s_mov_b32 s22, 1.0
    s_mov_b32 s23, 1.0
    s_mov_b32 s26, 0x3b072033
    s_mov_b32 s27, 0xffff0000
    s_mov_b32 s63, 40000
    s_waitcnt lgkmcnt(0)
    s_lshl_b32 s4, s8, 16
    s_and_b32 s5, s8, 0xffff0000
    s_lshl_b32 s6, s9, 16
    s_and_b32 s7, s9, 0xffff0000
    s_mov_b32 vcc_lo, 0
    s_mov_b32 vcc_hi, -1
    v_mov_b32 v11, s10
    v_mov_b32 v24, s11
    v_mov_b32 v14, s12
    v_mov_b32 v25, s13
    v_cndmask_b32 v11, v11, v24, vcc
    v_cndmask_b32 v14, v14, v25, vcc
    s_mov_b32 vcc_lo, 0xffff0000
    s_mov_b32 vcc_hi, 0xffff0000
    v_lshlrev_b32 v24, 16, v11
    v_lshlrev_b32 v25, 16, v14
    v_and_b32 v11, 0xffff0000, v11
    v_and_b32 v14, 0xffff0000, v14
    v_cndmask_b32 v11, v24, v11, vcc
    v_cndmask_b32 v14, v25, v14, vcc
    s_cmp_eq_u32 s61, 1
    s_cselect_b32 s48, 0, 8388608
    s_add_u32 s56, s56, s48
    s_add_u32 s57, s56, 32768
L_APOLL:
    s_sleep 1
    buffer_load_dword v44, v50, s[28:31], s59 offen offset:512 sc1
    s_sub_u32 s63, s63, 1
    s_waitcnt vmcnt(0)
    s_cmp_eq_u32 s63, 0
    s_cbranch_scc1 L_AGOT
    v_cmp_ne_u32 vcc, 1, v44
    s_cmp_eq_u64 vcc, 0
    s_cbranch_scc0 L_APOLL
L_AGOT:
    s_mov_b32 m0, s54
    s_mov_b32 s63, 40000
    buffer_load_dwordx4 v49, s[28:31], s62 offen offset:0 sc1 lds
    buffer_load_dwordx4 v49, s[28:31], s62 offen offset:1024 sc1 lds
    buffer_load_dwordx4 v49, s[28:31], s62 offen offset:2048 sc1 lds
    buffer_load_dwordx4 v49, s[28:31], s62 offen offset:3072 sc1 lds
    s_waitcnt vmcnt(0)
    s_barrier
    s_barrier
    s_branch L_POLL
L_CODE_END:
.section .rodata,"a"
.p2align 6
.amdhsa_kernel standalone__self_sup_conv_stem_hubert__speech_kernel
  .amdhsa_next_free_vgpr 233
  .amdhsa_next_free_sgpr 64
  .amdhsa_accum_offset 236
  .amdhsa_group_segment_fixed_size 0
  .amdhsa_kernarg_size 64
  .amdhsa_user_sgpr_count 2
  .amdhsa_user_sgpr_kernarg_segment_ptr 1
  .amdhsa_system_sgpr_workgroup_id_x 1
  .amdhsa_float_denorm_mode_32 3
.end_amdhsa_kernel
```
